```python
import torch

def _softmax(x, axis=-1):
    return torch.softmax(x, dim=axis)
def _gelu(x):
    return torch.nn.functional.gelu(x, approximate="tanh")
def _silu(x):
    return torch.nn.functional.silu(x)
def _sigmoid(x):
    return torch.sigmoid(x)
def _layernorm(x, axis=-1, eps=1e-5):
    m = x.mean(dim=axis, keepdim=True)
    v = x.var(dim=axis, keepdim=True, unbiased=False)
    return (x - m) / torch.sqrt(v + eps)
def _scatter_add(tgt, idx, src, axis=0):
    return tgt.clone().index_add_(axis, idx, src)
def _segment_sum(src, seg, n):
    out = torch.zeros((n,) + src.shape[1:], dtype=src.dtype)
    return out.index_add_(0, seg, src)
def _pad(x, pw):
    flat = tuple(v for pair in reversed(pw) for v in pair)
    return torch.nn.functional.pad(x, flat)

kernel_name = 'gated_mix__ssm_conv_s4__ssm_conv_h3__prompt'

def setup_inputs():

    _w = (lambda a: (lambda t: t.to(torch.bfloat16) if t.is_floating_point() else t)(torch.as_tensor(a)))
    def _A_setup():
        B, L, D, N = 1, 2048, 448, 256
        A_re = -(lambda _x: torch.exp(torch.as_tensor(_x)))((lambda *s: torch.randn(*s, dtype=torch.bfloat16) * 6.4)(D, N))
        A_im = torch.pi * (lambda *s: torch.randn(*s, dtype=torch.bfloat16) * 0.05)(D, N)
        B_re = (lambda *s: torch.randn(*s, dtype=torch.bfloat16) * 0.1)(D, N)
        B_im = (lambda *s: torch.randn(*s, dtype=torch.bfloat16) * 0.1)(D, N)
        C_re = (lambda *s: torch.randn(*s, dtype=torch.bfloat16) * 0.1)(D, N)
        C_im = (lambda *s: torch.randn(*s, dtype=torch.bfloat16) * 0.1)(D, N)
        log_dt = (lambda *s: torch.randn(*s, dtype=torch.bfloat16) * 0.05)(D) * 0.5 - 4.0
        Dskip = (lambda *s: torch.randn(*s, dtype=torch.bfloat16) * 0.05)(D)
        return {
            "u": _w((lambda *s: torch.randn(*s, dtype=torch.bfloat16) * 0.05)(B, L, D)),
            "A_re": _w(A_re),
            "A_im": _w(A_im),
            "B_re": _w(B_re),
            "B_im": _w(B_im),
            "C_re": _w(C_re),
            "C_im": _w(C_im),
            "log_dt": _w(log_dt),
            "Dskip": _w(Dskip),
        }
    _A_in = _A_setup()

    def _B_setup():
        B, S, D = 1, 2048, 448
        ks = 4
        return {
            "q": _w((lambda *s: torch.randn(*s, dtype=torch.bfloat16) * 0.05)(B, S, D)),
            "k": _w((lambda *s: torch.randn(*s, dtype=torch.bfloat16) * 0.4)(B, S, D)),
            "v": _w((lambda *s: torch.randn(*s, dtype=torch.bfloat16) * 0.4)(B, S, D)),
            "shift_k": _w((lambda *s: torch.randn(*s, dtype=torch.bfloat16) * 0.4)(D, ks) * 0.5),
            "ssm_k": _w((lambda *s: torch.randn(*s, dtype=torch.bfloat16) * 0.4)(D, S) * (1.0 / S ** 0.5)),
            "ssm_D": _w((lambda *s: torch.randn(*s, dtype=torch.bfloat16) * 0.4)(D)),
        }
    _B_in = _B_setup()

    return {
        "A_u": _A_in["u"],
        "A_A_re": _A_in["A_re"],
        "A_A_im": _A_in["A_im"],
        "A_B_re": _A_in["B_re"],
        "A_B_im": _A_in["B_im"],
        "A_C_re": _A_in["C_re"],
        "A_C_im": _A_in["C_im"],
        "A_log_dt": _A_in["log_dt"],
        "A_Dskip": _A_in["Dskip"],
        "B_q": _B_in["q"],
        "B_k": _B_in["k"],
        "B_v": _B_in["v"],
        "B_shift_k": _B_in["shift_k"],
        "B_ssm_k": _B_in["ssm_k"],
        "B_ssm_D": _B_in["ssm_D"],
        "gate_w": _w((lambda *s: torch.randn(*s, dtype=torch.bfloat16) * 0.05)(448) * 16.0),
    }

def reference(A_u, A_A_re, A_A_im, A_B_re, A_B_im, A_C_re, A_C_im, A_log_dt, A_Dskip, B_q, B_k, B_v, B_shift_k, B_ssm_k, B_ssm_D, gate_w):
    def _A_ref(u, A_re, A_im, B_re, B_im, C_re, C_im, log_dt, Dskip):
        Bsz, L, D = u.shape
        dt = torch.exp(log_dt)[:, None]
        A = A_re + 1j * A_im
        Bc = B_re + 1j * B_im
        Cc = C_re + 1j * C_im
        logdA = dt * A
        dB = dt * Bc
        l = (lambda x, dt: x.to(dt))(torch.arange(L), A_re.dtype)
        P = torch.exp(logdA[:, :, None] * l[None, None, :])
        K = torch.einsum("dn,dnl,dn->dl", Cc, P, dB).real
        L2 = 2 * L
        Kp = _pad(K, ((0, 0), (0, L)))
        up = (lambda x, *d: x.permute(*d))(u, 0, 2, 1)
        up = _pad(up, ((0, 0), (0, 0), (0, L)))
        Kf = (lambda x, axes=(-2,-1): torch.fft.rfft2(x.float(), dim=axes))(Kp[:, None, :], axes=(-2, -1))
        Uf = (lambda x, axes=(-2,-1): torch.fft.rfft2(x.float(), dim=axes))(up[:, :, None, :], axes=(-2, -1))
        Yf = Uf * Kf[None, :, :, :]
        y = (lambda x, s, axes=(-2,-1): torch.fft.irfft2(x, s=s, dim=axes).to(torch.bfloat16))(Yf, (1, L2), axes=(-2, -1))[:, :, 0, :L]
        y = (lambda x, *d: x.permute(*d))(y, 0, 2, 1) + u * Dskip[None, None, :]
        return y

    def _B_ref(q, k, v, shift_k, ssm_k, ssm_D):
        B, S, D = q.shape
        ks = shift_k.shape[-1]
        k_pad = _pad(k, ((0, 0), (ks - 1, 0), (0, 0)))
        k_shift = torch.zeros_like(k)
        for t in range(ks):
            k_shift = k_shift + k_pad[:, t:t + S, :] * shift_k[:, ks - 1 - t][None, None, :]
        kv = k_shift * v
        L = 2 * S
        kv_pad = _pad(kv, ((0, 0), (0, S), (0, 0)))
        kf_pad = _pad(ssm_k, ((0, 0), (0, S)))
        kv_f = (lambda x, axes=(-2,-1): torch.fft.rfft2(x.float(), dim=axes))(kv_pad[:, None, :, :], axes=(1, 2))
        kf_f = (lambda x, axes=(-2,-1): torch.fft.rfft2(x.float(), dim=axes))(kf_pad[:, None, :], axes=(1, 2))
        kf_f = (lambda x, *d: x.permute(*d))(kf_f, 1, 2, 0)
        y_f = kv_f * kf_f[None, :, :, :]
        y = (lambda x, s, axes=(-2,-1): torch.fft.irfft2(x, s=s, dim=axes).to(torch.bfloat16))(y_f, (1, L), axes=(1, 2))[:, 0, :S, :]
        y = y + kv * ssm_D[None, None, :]
        return q * y

    x = A_u
    g = _sigmoid((x * gate_w).sum(-1, keepdims=True))
    a = _A_ref(x, A_A_re, A_A_im, A_B_re, A_B_im, A_C_re, A_C_im, A_log_dt, A_Dskip)
    b = _B_ref(x, B_k, B_v, B_shift_k, B_ssm_k, B_ssm_D)
    return g * a + (1 - g) * b
```

```asm
; @launch grid=(256,1,1) block=(512,1,1) lds=132928
.amdgcn_target "amdgcn-amd-amdhsa--gfx950"
.text
.globl gated_mix__ssm_conv_s4__ssm_conv_h3__prompt_kernel
.p2align 8
.type gated_mix__ssm_conv_s4__ssm_conv_h3__prompt_kernel,@function
gated_mix__ssm_conv_s4__ssm_conv_h3__prompt_kernel:
    s_cmp_ge_u32 s2, 256
    s_cbranch_scc1 L_end
L_pc:
    s_getpc_b64 s[12:13]
L_pc3:
    s_lshr_b32 s5, s2, 3
    v_bfe_u32 v3, v0, 6, 2
    s_lshl_b32 s8, s5, 9
    s_load_dwordx16 s[32:47], s[0:1], 64
    v_lshl_add_u32 v3, v3, 7, s8
    v_min_u32 v3, L_codeend-L_pc3-4, v3
    global_load_dword v57, v3, s[12:13]
    s_load_dwordx16 s[16:31], s[0:1], 0
    v_lshrrev_b32 v2, 6, v0
    s_load_dwordx4 s[48:51], s[0:1], 128
    s_load_dwordx2 s[52:53], s[0:1], 144
    v_readfirstlane_b32 s6, v2
    v_and_b32 v1, 63, v0
    s_and_b32 s8, s2, 7
    s_lshl_b32 s8, s8, 2
    s_lshr_b32 s4, 0x65743210, s8
    s_and_b32 s4, s4, 7
    s_cmp_eq_u32 s4, 7
    s_cbranch_scc1 L_g7
    v_lshlrev_b32 v5, 2, v1
    v_mov_b32 v8, 0
    ds_write_b32 v5, v8 offset:0
    s_lshl_b32 s7, s4, 5
    s_add_u32 s7, s7, s5
    s_and_b32 s54, s6, 3
    s_lshr_b32 s55, s54, 1
    s_and_b32 s60, s6, 1
    s_cmp_ge_u32 s6, 4
    s_cbranch_scc0 L_tpre
L_kpre:
    s_lshl_b32 s11, s7, 1
    s_add_u32 s11, s11, s55
    s_lshl_b32 s14, s11, 9
    s_lshl_b32 s15, s60, 8
    s_add_u32 s14, s14, s15
    v_lshl_add_u32 v224, v1, 2, s14
    s_lshl_b32 s14, s7, 2
    s_waitcnt lgkmcnt(0)
    s_add_u32 s8, s2, s54
    s_cmp_eq_u32 s8, 0
    s_cbranch_scc1 L_mknon
L_nonon:
    global_load_dword v200, v224, s[18:19]
    global_load_dword v201, v224, s[20:21]
    global_load_dword v202, v224, s[22:23]
    global_load_dword v203, v224, s[24:25]
    global_load_dword v204, v224, s[26:27]
    global_load_dword v205, v224, s[28:29]
    s_load_dword s66, s[30:31], s14
    s_load_dword s67, s[32:33], s14
    s_barrier
    s_branch L_kmain2
L_tpre:
    s_lshl_b32 s8, s55, 5
    s_lshl_b32 s9, s5, 6
    s_add_u32 s8, s8, s9
    s_mul_i32 s8, s8, 896
    s_lshl_b32 s10, s60, 6
    s_lshl_b32 s11, s4, 7
    s_add_u32 s10, s10, s11
    s_add_u32 s8, s8, s10
    v_lshrrev_b32 v2, 4, v1
    v_and_b32 v3, 15, v1
    v_mul_u32_u24 v4, 7168, v2
    v_lshl_add_u32 v4, v3, 2, v4
    v_add_u32 v10, s8, v4
    v_add_u32 v11, 3584, v10
    v_subrev_u32 v12, 2688, v10
    s_lshl_b32 s10, s10, 2
    v_lshl_add_u32 v8, v3, 4, s10
    s_mov_b32 s58, 1835008
    s_mov_b32 s59, 0x20000
    s_waitcnt lgkmcnt(0)
    s_mov_b32 s56, s36
    s_mov_b32 s57, s37
    s_barrier
    buffer_load_dword v32, v12, s[56:59], 0 offen offset:0
    buffer_load_dword v33, v12, s[56:59], 0 offen offset:896
    buffer_load_dword v34, v12, s[56:59], 0 offen offset:1792
    buffer_load_dword v35, v10, s[56:59], 0 offen offset:0
    buffer_load_dword v36, v10, s[56:59], 0 offen offset:896
    buffer_load_dword v37, v10, s[56:59], 0 offen offset:1792
    buffer_load_dword v38, v10, s[56:59], 0 offen offset:2688
    buffer_load_dword v39, v11, s[56:59], 0 offen offset:0
    buffer_load_dword v40, v11, s[56:59], 0 offen offset:896
    buffer_load_dword v41, v11, s[56:59], 0 offen offset:1792
    buffer_load_dword v42, v11, s[56:59], 0 offen offset:2688
    global_load_dwordx4 v[44:47], v8, s[40:41]
    global_load_dword v24, v10, s[38:39] offset:0
    global_load_dword v25, v10, s[38:39] offset:896
    global_load_dword v26, v10, s[38:39] offset:1792
    global_load_dword v27, v10, s[38:39] offset:2688
    global_load_dword v28, v11, s[38:39] offset:0
    global_load_dword v29, v11, s[38:39] offset:896
    global_load_dword v30, v11, s[38:39] offset:1792
    global_load_dword v31, v11, s[38:39] offset:2688
    global_load_dword v16, v10, s[16:17] offset:0
    global_load_dword v17, v10, s[16:17] offset:896
    global_load_dword v18, v10, s[16:17] offset:1792
    global_load_dword v19, v10, s[16:17] offset:2688
    global_load_dword v20, v11, s[16:17] offset:0
    global_load_dword v21, v11, s[16:17] offset:896
    global_load_dword v22, v11, s[16:17] offset:1792
    global_load_dword v23, v11, s[16:17] offset:2688
    v_lshlrev_b32 v2, 4, v0
    s_lshl_b32 s9, s7, 13
    v_add_u32 v216, s9, v2
    v_add_u32 v219, 4096, v216
    v_add_u32 v217, 66272, v2
    v_lshrrev_b32 v2, 4, v1
    s_lshl_b32 s14, s7, 2
    s_load_dword s68, s[44:45], s14
    s_cmp_lg_u32 s54, 3
    s_cbranch_scc1 L_nopf
    s_lshl_b32 s9, s4, 13
    s_and_b32 s10, s5, 3
    s_lshl_b32 s10, s10, 7
    s_add_u32 s9, s9, s10
    s_add_u32 s9, s9, 3678208
    s_load_dword s92, s[52:53], s9
L_nopf:
    s_setprio 1
    s_mov_b32 s62, 0xffff0000
    s_mov_b32 s63, 0x05040100
    s_mov_b32 s64, 0x07060302
    s_lshl_b32 s8, s4, 5
    s_lshl_b32 s9, s60, 4
    s_add_u32 s8, s8, s9
    s_lshl_b32 s8, s8, 14
    s_lshl_b32 s9, s5, 9
    s_add_u32 s8, s8, s9
    s_lshl_b32 s9, s55, 6
    s_add_u32 s8, s8, s9
    v_lshlrev_b32 v9, 14, v3
    v_lshl_add_u32 v9, v2, 4, v9
    v_add_u32 v9, s8, v9
    v_mov_b32 v4, 0
    s_lshl_b32 s14, s54, 2
    s_add_u32 s14, s14, 0
    v_mov_b32 v226, s14
    v_and_b32 v2, 3, v1
    v_lshlrev_b32 v2, 2, v2
    v_add_u32 v228, 0, v2
    v_mov_b32 v229, 1
    s_lshl_b32 s8, s4, 13
    s_add_u32 s8, s8, 3678208
    s_lshr_b32 s9, s5, 4
    s_lshl_b32 s9, s9, 8
    s_add_u32 s9, s9, s8
    v_lshl_add_u32 v200, v1, 2, s9
    v_add_u32 v201, 4096, v200
    s_lshl_b32 s9, s60, 8
    s_add_u32 s8, s8, s9
    s_lshl_b32 s9, s5, 3
    s_add_u32 s8, s8, s9
    s_lshl_b32 s9, s55, 2
    s_add_u32 s8, s8, s9
    v_mov_b32 v202, s8
    v_add_u32 v203, 4096, v202
    s_lshl_b32 s8, s7, 14
    v_lshlrev_b32 v2, 4, v0
    v_add_u32 v204, s8, v2
    v_add_u32 v205, 4096, v204
    v_add_u32 v206, 8192, v204
    v_add_u32 v207, 12288, v204
    v_lshrrev_b32 v2, 4, v1
    v_lshlrev_b32 v2, 10, v2
    v_and_b32 v3, 15, v1
    v_lshl_add_u32 v2, v3, 4, v2
    s_lshl_b32 s9, s6, 8
    v_add_u32 v2, s9, v2
    v_add_u32 v208, 3670016, v2
    v_add_u32 v209, 3674112, v2
    v_add_u32 v211, 91968, v2
    v_and_b32 v2, 3, v0
    v_mul_u32_u24 v210, 1088, v2
    v_bfe_u32 v2, v0, 3, 2
    v_mul_u32_u24 v3, 4352, v2
    v_add_u32 v210, v210, v3
    v_bfe_u32 v2, v0, 2, 1
    v_lshlrev_b32 v2, 4, v2
    v_lshrrev_b32 v3, 5, v0
    v_lshl_add_u32 v2, v3, 5, v2
    v_sub_u32 v210, v210, v2
    v_add_u32 v210, 74800, v210
    v_lshlrev_b32 v2, 2, v0
    v_add_u32 v212, 100160, v2
    v_add_u32 v214, 91968, v2
    v_mul_u32_u24 v215, 896, v0
    s_lshl_b32 s9, s7, 2
    v_add_u32 v215, s9, v215
    v_and_b32 v2, 3, v1
    v_mul_u32_u24 v3, 1088, v2
    v_lshrrev_b32 v2, 2, v0
    v_lshlrev_b32 v2, 1, v2
    v_sub_u32 v3, v3, v2
    v_add_u32 v213, 75582, v3
    s_waitcnt vmcnt(25)
    v_lshlrev_b32 v64, 16, v32
    v_and_b32 v65, s62, v32
    v_lshlrev_b32 v66, 16, v33
    v_and_b32 v67, s62, v33
    v_lshlrev_b32 v68, 16, v34
    v_and_b32 v69, s62, v34
    s_waitcnt vmcnt(16)
    v_lshlrev_b32 v70, 16, v35
    v_and_b32 v71, s62, v35
    v_lshlrev_b32 v72, 16, v36
    v_and_b32 v73, s62, v36
    v_lshlrev_b32 v74, 16, v37
    v_and_b32 v75, s62, v37
    v_lshlrev_b32 v76, 16, v38
    v_and_b32 v77, s62, v38
    v_lshlrev_b32 v78, 16, v39
    v_and_b32 v79, s62, v39
    v_lshlrev_b32 v80, 16, v40
    v_and_b32 v81, s62, v40
    v_lshlrev_b32 v82, 16, v41
    v_and_b32 v83, s62, v41
    v_lshlrev_b32 v84, 16, v42
    v_and_b32 v85, s62, v42
    v_lshlrev_b32 v86, 16, v44
    v_and_b32 v88, s62, v44
    v_lshlrev_b32 v90, 16, v45
    v_and_b32 v92, s62, v45
    v_lshlrev_b32 v87, 16, v46
    v_and_b32 v89, s62, v46
    v_lshlrev_b32 v91, 16, v47
    v_and_b32_e64 v93, s62, v47
    v_pk_mul_f32 v[96:97], v[70:71], v[86:87]
    v_pk_mul_f32 v[98:99], v[72:73], v[86:87]
    v_pk_mul_f32 v[100:101], v[74:75], v[86:87]
    v_pk_mul_f32 v[102:103], v[76:77], v[86:87]
    v_pk_mul_f32 v[104:105], v[78:79], v[86:87]
    v_pk_mul_f32 v[106:107], v[80:81], v[86:87]
    v_pk_mul_f32 v[108:109], v[82:83], v[86:87]
    v_pk_mul_f32 v[110:111], v[84:85], v[86:87]
    v_pk_fma_f32 v[96:97], v[68:69], v[88:89], v[96:97]
    v_pk_fma_f32 v[98:99], v[70:71], v[88:89], v[98:99]
    v_pk_fma_f32 v[100:101], v[72:73], v[88:89], v[100:101]
    v_pk_fma_f32 v[102:103], v[74:75], v[88:89], v[102:103]
    v_pk_fma_f32 v[104:105], v[76:77], v[88:89], v[104:105]
    v_pk_fma_f32 v[106:107], v[78:79], v[88:89], v[106:107]
    v_pk_fma_f32 v[108:109], v[80:81], v[88:89], v[108:109]
    v_pk_fma_f32 v[110:111], v[82:83], v[88:89], v[110:111]
    v_pk_fma_f32 v[96:97], v[66:67], v[90:91], v[96:97]
    v_pk_fma_f32 v[98:99], v[68:69], v[90:91], v[98:99]
    v_pk_fma_f32 v[100:101], v[70:71], v[90:91], v[100:101]
    v_pk_fma_f32 v[102:103], v[72:73], v[90:91], v[102:103]
    v_pk_fma_f32 v[104:105], v[74:75], v[90:91], v[104:105]
    v_pk_fma_f32 v[106:107], v[76:77], v[90:91], v[106:107]
    v_pk_fma_f32 v[108:109], v[78:79], v[90:91], v[108:109]
    v_pk_fma_f32 v[110:111], v[80:81], v[90:91], v[110:111]
    v_pk_fma_f32 v[96:97], v[64:65], v[92:93], v[96:97]
    v_pk_fma_f32 v[98:99], v[66:67], v[92:93], v[98:99]
    v_pk_fma_f32 v[100:101], v[68:69], v[92:93], v[100:101]
    v_pk_fma_f32 v[102:103], v[70:71], v[92:93], v[102:103]
    v_pk_fma_f32 v[104:105], v[72:73], v[92:93], v[104:105]
    v_pk_fma_f32 v[106:107], v[74:75], v[92:93], v[106:107]
    v_pk_fma_f32 v[108:109], v[76:77], v[92:93], v[108:109]
    v_pk_fma_f32 v[110:111], v[78:79], v[92:93], v[110:111]
    s_waitcnt vmcnt(8)
    v_lshlrev_b32 v112, 16, v24
    v_and_b32_e64 v113, s62, v24
    v_pk_mul_f32 v[96:97], v[96:97], v[112:113]
    v_lshlrev_b32 v114, 16, v25
    v_and_b32 v115, s62, v25
    v_pk_mul_f32 v[98:99], v[98:99], v[114:115]
    v_lshlrev_b32 v116, 16, v26
    v_and_b32 v117, s62, v26
    v_pk_mul_f32 v[100:101], v[100:101], v[116:117]
    v_lshlrev_b32 v118, 16, v27
    v_and_b32 v119, s62, v27
    v_pk_mul_f32 v[102:103], v[102:103], v[118:119]
    v_lshlrev_b32 v112, 16, v28
    v_and_b32 v113, s62, v28
    v_pk_mul_f32 v[104:105], v[104:105], v[112:113]
    v_lshlrev_b32 v114, 16, v29
    v_and_b32 v115, s62, v29
    v_pk_mul_f32 v[106:107], v[106:107], v[114:115]
    v_lshlrev_b32 v116, 16, v30
    v_and_b32 v117, s62, v30
    v_pk_mul_f32 v[108:109], v[108:109], v[116:117]
    v_lshlrev_b32 v118, 16, v31
    v_and_b32 v119, s62, v31
    v_pk_mul_f32 v[110:111], v[110:111], v[118:119]
    v_cvt_pk_bf16_f32 v131, v104, v96
    v_cvt_pk_bf16_f32 v130, v106, v98
    v_cvt_pk_bf16_f32 v129, v108, v100
    v_cvt_pk_bf16_f32 v128, v110, v102
    v_cvt_pk_bf16_f32 v135, v105, v97
    v_cvt_pk_bf16_f32 v134, v107, v99
    v_cvt_pk_bf16_f32 v133, v109, v101
    v_cvt_pk_bf16_f32 v132, v111, v103
    v_permlane32_swap_b32 v131, v129
    v_permlane32_swap_b32 v130, v128
    v_permlane32_swap_b32 v135, v133
    v_permlane32_swap_b32 v134, v132
    v_permlane16_swap_b32 v131, v130
    v_permlane16_swap_b32 v129, v128
    v_permlane16_swap_b32 v135, v134
    v_permlane16_swap_b32 v133, v132
    global_store_dwordx4 v9, v[128:131], s[52:53] offset:256 sc1
    global_store_dwordx4 v9, v[132:135], s[52:53] offset:384 sc1
    s_waitcnt vmcnt(2)
    s_nop 0
    v_perm_b32 v123, v16, v20, s63
    v_perm_b32 v122, v17, v21, s63
    v_perm_b32 v121, v18, v22, s63
    v_perm_b32 v120, v19, v23, s63
    v_perm_b32 v127, v16, v20, s64
    v_perm_b32 v126, v17, v21, s64
    v_perm_b32 v125, v18, v22, s64
    v_perm_b32 v124, v19, v23, s64
    v_permlane32_swap_b32 v123, v121
    v_permlane32_swap_b32 v122, v120
    v_permlane32_swap_b32 v127, v125
    v_permlane32_swap_b32 v126, v124
    v_permlane16_swap_b32 v123, v122
    v_permlane16_swap_b32 v121, v120
    v_permlane16_swap_b32 v127, v126
    v_permlane16_swap_b32 v125, v124
    global_store_dwordx4 v9, v[120:123], s[52:53] offset:0 sc1
    global_store_dwordx4 v9, v[124:127], s[52:53] offset:128 sc1
    global_load_dword v63, v4, s[50:51] sc1
    global_load_dwordx4 v[48:51], v216, s[42:43]
    global_load_dwordx4 v[52:55], v219, s[42:43]
    v_cmp_eq_u32 vcc, 0, v0
    s_waitcnt lgkmcnt(0)
    v_mov_b32 v2, s68
    v_cndmask_b32 v218, 0, v2, vcc
    v_mov_b32 v30, 0
    v_mov_b32 v31, 0
    v_lshlrev_b32 v72, 16, v218
    v_and_b32 v73, s62, v218
    v_mov_b32 v74, 0xffff
    s_waitcnt vmcnt(2)
    s_mov_b32 s65, 0
L_nona:
    v_readfirstlane_b32 s70, v63
    s_nop 0
    s_cmp_lg_u32 s70, 0
    s_cbranch_scc1 L_nona_ok
    s_sleep 4
    global_load_dword v63, v4, s[50:51] sc1
    s_waitcnt vmcnt(0)
    s_add_u32 s65, s65, 1
    s_bitcmp0_b32 s65, 16
    s_cbranch_scc1 L_nona
L_nona_ok:
    s_mov_b64 exec, 1
    global_store_dword v202, v63, s[52:53]
    s_mov_b64 exec, -1
    global_load_dword v19, v200, s[52:53] sc1
    s_mov_b32 s65, 0
    s_mov_b32 s3, 0
    s_lshl_b32 s13, s6, 2
    s_waitcnt vmcnt(0)
    v_cmp_eq_u32 s[10:11], s70, v19
    v_lshlrev_b32 v75, 16, v48
    v_add_f32 v75, v75, v72
    v_cvt_pk_bf16_f32 v75, v75, v75
    v_bfi_b32 v48, v74, v75, v48
    ds_write_b128 v217, v[48:51] offset:0
    v_lshlrev_b32 v75, 16, v52
    v_add_f32 v75, v75, v73
    v_cvt_pk_bf16_f32 v75, v75, v75
    v_bfi_b32 v52, v74, v75, v52
    ds_write_b128 v217, v[52:55] offset:4160
    ds_write_b32 v226, v229 offset:192
    s_branch L_chk0
L_poll0:
    s_add_u32 s65, s65, 1
    s_cmp_lg_u32 s65, 16
    s_cbranch_scc1 L_nob0
    s_mov_b64 exec, 1
    global_store_dword v203, v63, s[52:53] sc1
    s_mov_b64 exec, -1
L_nob0:
    s_and_b32 s8, s65, 63
    s_cbranch_scc0 L_pollb0
    global_load_dword v19, v200, s[52:53] sc1
    s_branch L_pollc0
L_pollb0:
    global_load_dword v19, v201, s[52:53] sc1
L_pollc0:
    s_waitcnt vmcnt(0)
    v_cmp_eq_u32 vcc, s70, v19
    s_nop 0
    s_or_b64 s[10:11], s[10:11], vcc
    s_bitcmp1_b32 s65, 17
    s_cbranch_scc1 L_iss0
L_chk0:
    s_lshr_b32 s8, s10, s13
    s_and_b32 s8, s8, 15
    s_cmp_eq_u32 s8, 15
    s_cbranch_scc0 L_poll0
L_iss0:
    global_load_dwordx4 v[136:139], v204, s[52:53] sc1
    s_branch L_chk1
L_poll1:
    s_cmp_gt_u32 s3, 0
    s_cbranch_scc1 L_put1_0
    s_waitcnt vmcnt(0)
    ds_write_b128 v210, v[136:139] offset:768
    ds_write_b32 v226, v229 offset:0
    s_mov_b32 s3, 1
L_put1_0:
    s_add_u32 s65, s65, 1
    s_cmp_lg_u32 s65, 16
    s_cbranch_scc1 L_nob1
    s_mov_b64 exec, 1
    global_store_dword v203, v63, s[52:53] sc1
    s_mov_b64 exec, -1
L_nob1:
    s_and_b32 s8, s65, 63
    s_cbranch_scc0 L_pollb1
    global_load_dword v19, v200, s[52:53] sc1
    s_branch L_pollc1
L_pollb1:
    global_load_dword v19, v201, s[52:53] sc1
L_pollc1:
    s_waitcnt vmcnt(0)
    v_cmp_eq_u32 vcc, s70, v19
    s_nop 0
    s_or_b64 s[10:11], s[10:11], vcc
    s_bitcmp1_b32 s65, 17
    s_cbranch_scc1 L_iss1
L_chk1:
    s_lshr_b32 s8, s10, s13
    s_lshr_b32 s8, s8, 16
    s_and_b32 s8, s8, 15
    s_cmp_eq_u32 s8, 15
    s_cbranch_scc0 L_poll1
L_iss1:
    global_load_dwordx4 v[140:143], v205, s[52:53] sc1
    s_branch L_chk2
L_poll2:
    s_cmp_gt_u32 s3, 0
    s_cbranch_scc1 L_put2_0
    s_waitcnt vmcnt(0)
    ds_write_b128 v210, v[136:139] offset:768
    ds_write_b32 v226, v229 offset:0
    s_mov_b32 s3, 1
L_put2_0:
    s_cmp_gt_u32 s3, 1
    s_cbranch_scc1 L_put2_1
    s_waitcnt vmcnt(0)
    ds_write_b128 v210, v[140:143] offset:512
    ds_write_b32 v226, v229 offset:32
    s_mov_b32 s3, 2
L_put2_1:
    s_add_u32 s65, s65, 1
    s_cmp_lg_u32 s65, 16
    s_cbranch_scc1 L_nob2
    s_mov_b64 exec, 1
    global_store_dword v203, v63, s[52:53] sc1
    s_mov_b64 exec, -1
L_nob2:
    s_and_b32 s8, s65, 63
    s_cbranch_scc0 L_pollb2
    global_load_dword v19, v200, s[52:53] sc1
    s_branch L_pollc2
L_pollb2:
    global_load_dword v19, v201, s[52:53] sc1
L_pollc2:
    s_waitcnt vmcnt(0)
    v_cmp_eq_u32 vcc, s70, v19
    s_nop 0
    s_or_b64 s[10:11], s[10:11], vcc
    s_bitcmp1_b32 s65, 17
    s_cbranch_scc1 L_iss2
L_chk2:
    s_lshr_b32 s8, s11, s13
    s_and_b32 s8, s8, 15
    s_cmp_eq_u32 s8, 15
    s_cbranch_scc0 L_poll2
L_iss2:
    global_load_dwordx4 v[144:147], v206, s[52:53] sc1
    s_branch L_chk3
L_poll3:
    s_cmp_gt_u32 s3, 0
    s_cbranch_scc1 L_put3_0
    s_waitcnt vmcnt(0)
    ds_write_b128 v210, v[136:139] offset:768
    ds_write_b32 v226, v229 offset:0
    s_mov_b32 s3, 1
L_put3_0:
    s_cmp_gt_u32 s3, 1
    s_cbranch_scc1 L_put3_1
    s_waitcnt vmcnt(0)
    ds_write_b128 v210, v[140:143] offset:512
    ds_write_b32 v226, v229 offset:32
    s_mov_b32 s3, 2
L_put3_1:
    s_cmp_gt_u32 s3, 2
    s_cbranch_scc1 L_put3_2
    s_waitcnt vmcnt(0)
    ds_write_b128 v210, v[144:147] offset:256
    ds_write_b32 v226, v229 offset:64
    s_mov_b32 s3, 3
L_put3_2:
    s_add_u32 s65, s65, 1
    s_cmp_lg_u32 s65, 16
    s_cbranch_scc1 L_nob3
    s_mov_b64 exec, 1
    global_store_dword v203, v63, s[52:53] sc1
    s_mov_b64 exec, -1
L_nob3:
    s_and_b32 s8, s65, 63
    s_cbranch_scc0 L_pollb3
    global_load_dword v19, v200, s[52:53] sc1
    s_branch L_pollc3
L_pollb3:
    global_load_dword v19, v201, s[52:53] sc1
L_pollc3:
    s_waitcnt vmcnt(0)
    v_cmp_eq_u32 vcc, s70, v19
    s_nop 0
    s_or_b64 s[10:11], s[10:11], vcc
    s_bitcmp1_b32 s65, 17
    s_cbranch_scc1 L_iss3
L_chk3:
    s_lshr_b32 s8, s11, s13
    s_lshr_b32 s8, s8, 16
    s_and_b32 s8, s8, 15
    s_cmp_eq_u32 s8, 15
    s_cbranch_scc0 L_poll3
L_iss3:
    global_load_dwordx4 v[148:151], v207, s[52:53] sc1
    global_load_dwordx4 v[152:155], v208, s[52:53] sc1
    global_load_dwordx4 v[156:159], v209, s[52:53] sc1
    s_mov_b64 exec, 1
    global_store_dword v203, v63, s[52:53] sc1
    s_mov_b64 exec, -1
    s_cmp_gt_u32 s3, 0
    s_cbranch_scc1 L_pute_0
    s_waitcnt vmcnt(6)
    ds_write_b128 v210, v[136:139] offset:768
    ds_write_b32 v226, v229 offset:0
    s_mov_b32 s3, 1
L_pute_0:
    s_cmp_gt_u32 s3, 1
    s_cbranch_scc1 L_pute_1
    s_waitcnt vmcnt(5)
    ds_write_b128 v210, v[140:143] offset:512
    ds_write_b32 v226, v229 offset:32
    s_mov_b32 s3, 2
L_pute_1:
    s_cmp_gt_u32 s3, 2
    s_cbranch_scc1 L_pute_2
    s_waitcnt vmcnt(4)
    ds_write_b128 v210, v[144:147] offset:256
    ds_write_b32 v226, v229 offset:64
    s_mov_b32 s3, 3
L_pute_2:
    s_cmp_gt_u32 s3, 3
    s_cbranch_scc1 L_pute_3
    s_waitcnt vmcnt(3)
    ds_write_b128 v210, v[148:151] offset:0
    ds_write_b32 v226, v229 offset:96
    s_mov_b32 s3, 4
L_pute_3:
    s_setprio 0
    s_mov_b32 s65, 0
    s_waitcnt vmcnt(1)
L_gchk:
    v_cmp_ne_u32 vcc, s70, v153
    v_cmp_ne_u32 s[8:9], s70, v155
    v_cmp_ne_u32 s[12:13], s70, v157
    v_cmp_ne_u32 s[14:15], s70, v159
    s_or_b64 s[8:9], s[8:9], vcc
    s_or_b64 s[12:13], s[12:13], s[14:15]
    s_or_b64 s[8:9], s[8:9], s[12:13]
    s_cbranch_scc0 L_gok
    s_sleep 4
    global_load_dwordx4 v[152:155], v208, s[52:53] sc1
    global_load_dwordx4 v[156:159], v209, s[52:53] sc1
    s_waitcnt vmcnt(0)
    s_add_u32 s65, s65, 1
    s_bitcmp0_b32 s65, 16
    s_cbranch_scc1 L_gchk
L_gok:
    v_and_b32 v155, s62, v154
    v_lshlrev_b32 v154, 16, v154
    v_and_b32 v153, s62, v152
    v_lshlrev_b32 v152, 16, v152
    ds_write_b128 v211, v[152:155] offset:0
    v_and_b32 v159, s62, v158
    v_lshlrev_b32 v158, 16, v158
    v_and_b32 v157, s62, v156
    v_lshlrev_b32 v156, 16, v156
    ds_write_b128 v211, v[156:159] offset:4096
    s_add_u32 s9, s6, 1
    s_mov_b32 s10, 0
L_help0:
L_help:
    s_mov_b32 s65, 0
L_hwait:
    ds_read_b32 v3, v228 offset:160
    s_waitcnt lgkmcnt(0)
    v_cmp_gt_u32 vcc, s9, v3
    s_cbranch_vccz L_hgo
    s_sleep 1
    s_add_u32 s65, s65, 1
    s_bitcmp0_b32 s65, 19
    s_cbranch_scc1 L_hwait
L_hgo:
    ds_read_b32 v28, v212 offset:16384
    ds_read_b32 v29, v212 offset:24576
    ds_read_u16_d16_hi v30, v213
    ds_read_u16_d16_hi v31, v213 offset:4352
    ds_read_b32 v26, v212
    ds_read_b32 v27, v212 offset:8192
    ds_read_b32 v25, v214
    v_add_u32 v212, 1024, v212
    v_add_u32 v214, 1024, v214
    v_subrev_u32 v213, 128, v213
    s_add_u32 s9, s9, 4
    s_add_u32 s10, s10, 1
    s_waitcnt lgkmcnt(0)
    v_mul_f32 v28, v28, v30
    v_mul_f32 v29, v29, v31
    v_sub_f32 v26, v26, v28
    v_sub_f32 v27, v27, v29
    v_fmac_f32 v28, v25, v26
    v_fmac_f32 v29, v25, v27
    v_cvt_pk_bf16_f32 v32, v28, v29
    global_store_dword v215, v32, s[48:49]
L_nost:
    v_add_u32 v215, 229376, v215
    s_cmp_lt_u32 s10, 7
    s_cbranch_scc1 L_help0
    ds_read_u16_d16_hi v30, v213
    ds_read_u16_d16_hi v31, v213 offset:4352
    ds_read_b32 v25, v214
    s_mov_b32 s65, 0
L_lw:
    ds_read_b32 v3, v228 offset:160
    ds_read_b32 v28, v212 offset:16384
    ds_read_b32 v29, v212 offset:24576
    ds_read_b32 v26, v212
    ds_read_b32 v27, v212 offset:8192
    s_waitcnt lgkmcnt(4)
    v_cmp_gt_u32 vcc, s9, v3
    s_cbranch_vccz L_lgo
    s_waitcnt lgkmcnt(0)
    s_add_u32 s65, s65, 1
    s_bitcmp0_b32 s65, 19
    s_cbranch_scc1 L_lw
L_lgo:
    s_waitcnt lgkmcnt(2)
    v_mul_f32 v28, v28, v30
    v_mul_f32 v29, v29, v31
    s_waitcnt lgkmcnt(0)
    v_sub_f32 v26, v26, v28
    v_sub_f32 v27, v27, v29
    v_fmac_f32 v28, v25, v26
    v_fmac_f32 v29, v25, v27
    v_cvt_pk_bf16_f32 v32, v28, v29
    global_store_dword v215, v32, s[48:49]
L_hend:
    s_endpgm
L_kmain:
    s_barrier
L_kmain2:
    s_mov_b32 s62, 0xffff0000
    s_mul_i32 s11, s54, 14416
    s_add_u32 s11, s11, 256
    s_mov_b32 m0, s11
    v_and_b32 v13, 31, v1
    v_lshrrev_b32 v14, 5, v1
    v_lshl_add_u32 v218, v1, 2, s11
    v_mul_u32_u24 v15, 272, v13
    v_lshl_add_u32 v15, v14, 4, v15
    v_add_u32 v219, s11, v15
    v_add_u32 v220, 5712, v219
    s_mov_b32 s69, 0x3e22f983
    s_mov_b32 s61, 0
    v_mov_b32 v12, 0x3f80
    s_lshl_b32 s14, s55, 4
    s_sub_u32 s14, 16, s14
    v_mov_b32 v11, 0x3fb8aa3b
    ds_write_b32 v218, v12 offset:5712
    s_waitcnt lgkmcnt(0)
    s_lshl_b32 s66, s66, s14
    s_and_b32 s66, s66, s62
    v_mov_b32 v13, s66
    v_mul_f32 v14, 0x3fb8aa3b, v13
    v_fma_f32 v15, v13, v11, -v14
    v_fmac_f32 v15, 0x32a57060, v13
    v_exp_f32 v14, v14
    v_mul_f32 v15, 0x3f317218, v15
    s_lshl_b32 s67, s67, s14
    v_fma_f32 v14, v14, v15, v14
    s_and_b32 s67, s67, s62
    v_cvt_pk_bf16_f32 v14, 0, v14
    s_cmp_eq_u32 s60, 0
    s_cselect_b32 s67, s67, 0
    v_readfirstlane_b32 s66, v14
    s_waitcnt vmcnt(0)
    v_lshlrev_b32 v8, 16, v200
    v_lshlrev_b32 v9, 16, v201
    v_lshlrev_b32 v10, 16, v202
    v_lshlrev_b32 v11, 16, v203
    v_lshlrev_b32 v12, 16, v204
    v_lshlrev_b32 v13, 16, v205
    v_mul_f32 v8, s66, v8
    v_mul_f32 v9, s66, v9
    v_mul_f32 v140, 0x3fb8aa3b, v8
    v_mul_f32_e64 v141, s69, v9
    v_fma_f32 v142, v9, s69, -v141
    v_fmac_f32 v142, 0x31dc9c88, v9
    v_exp_f32 v136, v140
    v_fract_f32 v137, v141
    v_mul_f32 v138, 0x41000000, v140
    v_mul_f32 v139, 0x41000000, v141
    v_exp_f32 v138, v138
    v_fract_f32 v139, v139
    v_mul_f32 v144, 0x43800000, v140
    v_mul_f32 v145, 0x43800000, v141
    v_exp_f32 v144, v144
    v_fract_f32 v145, v145
    v_add_f32_e64 v137, v137, v142
    v_fmac_f32 v139, 0x41000000, v142
    v_fmac_f32 v145, 0x43800000, v142
    v_cos_f32 v146, v137
    v_sin_f32 v147, v137
    v_cos_f32 v152, v139
    v_sin_f32 v153, v139
    v_cos_f32 v154, v145
    v_sin_f32 v155, v145
L_round:
    v_pk_mul_f32 v[156:157], v[12:13], v[10:11] op_sel_hi:[0,1]
    v_pk_fma_f32 v[156:157], v[12:13], v[10:11], v[156:157] op_sel:[1,1,0] op_sel_hi:[1,0,1] neg_lo:[1,0,0]
    v_pk_mul_f32 v[146:147], v[146:147], v[136:137] op_sel_hi:[1,0]
    v_pk_mul_f32 v[152:153], v[152:153], v[138:139] op_sel_hi:[1,0]
    v_pk_mul_f32 v[154:155], v[154:155], v[144:145] op_sel_hi:[1,0]
    v_mul_f32 v156, s66, v156
    v_mul_f32 v157, s66, v157
    v_pk_mul_f32 v[148:149], v[146:147], v[146:147] op_sel_hi:[0,1]
    v_pk_fma_f32 v[148:149], v[146:147], v[146:147], v[148:149] op_sel:[1,1,0] op_sel_hi:[1,0,1] neg_lo:[1,0,0]
    v_pk_mul_f32 v[150:151], v[148:149], v[148:149] op_sel_hi:[0,1]
    v_pk_fma_f32 v[150:151], v[148:149], v[148:149], v[150:151] op_sel:[1,1,0] op_sel_hi:[1,0,1] neg_lo:[1,0,0]
    v_cvt_pk_bf16_f32 v166, v152, v153
    v_cvt_pk_bf16_f32 v167, v156, -v157
    v_pk_mul_f32 v[162:163], v[152:153], v[152:153] op_sel_hi:[0,1]
    v_pk_mul_f32 v[158:159], v[156:157], v[146:147] op_sel_hi:[0,1]
    ds_write_addtid_b32 v166 offset:5984
    v_pk_fma_f32 v[162:163], v[152:153], v[152:153], v[162:163] op_sel:[1,1,0] op_sel_hi:[1,0,1] neg_lo:[1,0,0]
    v_pk_fma_f32 v[158:159], v[156:157], v[146:147], v[158:159] op_sel:[1,1,0] op_sel_hi:[1,0,1] neg_lo:[1,0,0]
    ds_write_addtid_b32 v167 offset:0
    v_cvt_pk_bf16_f32 v168, v162, v163
    v_cvt_pk_bf16_f32 v169, v158, -v159
    v_pk_mul_f32 v[164:165], v[162:163], v[152:153] op_sel_hi:[0,1]
    v_pk_mul_f32 v[160:161], v[158:159], v[146:147] op_sel_hi:[0,1]
    ds_write_addtid_b32 v168 offset:6256
    v_pk_fma_f32 v[164:165], v[162:163], v[152:153], v[164:165] op_sel:[1,1,0] op_sel_hi:[1,0,1] neg_lo:[1,0,0]
    v_pk_fma_f32 v[160:161], v[158:159], v[146:147], v[160:161] op_sel:[1,1,0] op_sel_hi:[1,0,1] neg_lo:[1,0,0]
    ds_write_addtid_b32 v169 offset:272
    v_cvt_pk_bf16_f32 v170, v164, v165
    v_cvt_pk_bf16_f32 v171, v160, -v161
    v_pk_mul_f32 v[162:163], v[164:165], v[152:153] op_sel_hi:[0,1]
    v_pk_mul_f32 v[158:159], v[160:161], v[146:147] op_sel_hi:[0,1]
    ds_write_addtid_b32 v170 offset:6528
    v_pk_fma_f32 v[162:163], v[164:165], v[152:153], v[162:163] op_sel:[1,1,0] op_sel_hi:[1,0,1] neg_lo:[1,0,0]
    v_pk_fma_f32 v[158:159], v[160:161], v[146:147], v[158:159] op_sel:[1,1,0] op_sel_hi:[1,0,1] neg_lo:[1,0,0]
    ds_write_addtid_b32 v171 offset:544
    v_cvt_pk_bf16_f32 v172, v162, v163
    v_cvt_pk_bf16_f32 v173, v158, -v159
    v_pk_mul_f32 v[164:165], v[162:163], v[152:153] op_sel_hi:[0,1]
    v_pk_mul_f32 v[160:161], v[158:159], v[146:147] op_sel_hi:[0,1]
    ds_write_addtid_b32 v172 offset:6800
    v_pk_fma_f32 v[164:165], v[162:163], v[152:153], v[164:165] op_sel:[1,1,0] op_sel_hi:[1,0,1] neg_lo:[1,0,0]
    v_pk_fma_f32 v[160:161], v[158:159], v[146:147], v[160:161] op_sel:[1,1,0] op_sel_hi:[1,0,1] neg_lo:[1,0,0]
    ds_write_addtid_b32 v173 offset:816
    v_cvt_pk_bf16_f32 v166, v164, v165
    v_cvt_pk_bf16_f32 v167, v160, -v161
    v_pk_mul_f32 v[162:163], v[164:165], v[152:153] op_sel_hi:[0,1]
    v_pk_mul_f32 v[158:159], v[160:161], v[146:147] op_sel_hi:[0,1]
    ds_write_addtid_b32 v166 offset:7072
    v_pk_fma_f32 v[162:163], v[164:165], v[152:153], v[162:163] op_sel:[1,1,0] op_sel_hi:[1,0,1] neg_lo:[1,0,0]
    v_pk_fma_f32 v[158:159], v[160:161], v[146:147], v[158:159] op_sel:[1,1,0] op_sel_hi:[1,0,1] neg_lo:[1,0,0]
    ds_write_addtid_b32 v167 offset:1088
    v_cvt_pk_bf16_f32 v168, v162, v163
    v_cvt_pk_bf16_f32 v169, v158, -v159
    v_pk_mul_f32 v[164:165], v[162:163], v[152:153] op_sel_hi:[0,1]
    v_pk_mul_f32 v[160:161], v[158:159], v[146:147] op_sel_hi:[0,1]
    ds_write_addtid_b32 v168 offset:7344
    v_pk_fma_f32 v[164:165], v[162:163], v[152:153], v[164:165] op_sel:[1,1,0] op_sel_hi:[1,0,1] neg_lo:[1,0,0]
    v_pk_fma_f32 v[160:161], v[158:159], v[146:147], v[160:161] op_sel:[1,1,0] op_sel_hi:[1,0,1] neg_lo:[1,0,0]
    ds_write_addtid_b32 v169 offset:1360
    v_cvt_pk_bf16_f32 v170, v164, v165
    v_cvt_pk_bf16_f32 v171, v160, -v161
    v_pk_mul_f32 v[162:163], v[164:165], v[152:153] op_sel_hi:[0,1]
    v_pk_mul_f32 v[158:159], v[160:161], v[146:147] op_sel_hi:[0,1]
    ds_write_addtid_b32 v170 offset:7616
    v_pk_fma_f32 v[162:163], v[164:165], v[152:153], v[162:163] op_sel:[1,1,0] op_sel_hi:[1,0,1] neg_lo:[1,0,0]
    v_pk_fma_f32 v[158:159], v[160:161], v[146:147], v[158:159] op_sel:[1,1,0] op_sel_hi:[1,0,1] neg_lo:[1,0,0]
    ds_write_addtid_b32 v171 offset:1632
    v_cvt_pk_bf16_f32 v172, v162, v163
    v_cvt_pk_bf16_f32 v173, v158, -v159
    v_pk_mul_f32 v[164:165], v[162:163], v[152:153] op_sel_hi:[0,1]
    v_pk_mul_f32 v[14:15], v[156:157], v[154:155] op_sel_hi:[0,1]
    ds_write_addtid_b32 v172 offset:7888
    v_pk_fma_f32 v[164:165], v[162:163], v[152:153], v[164:165] op_sel:[1,1,0] op_sel_hi:[1,0,1] neg_lo:[1,0,0]
    v_pk_fma_f32 v[156:157], v[156:157], v[154:155], v[14:15] op_sel:[1,1,0] op_sel_hi:[1,0,1] neg_lo:[1,0,0]
    ds_write_addtid_b32 v173 offset:1904
    v_cvt_pk_bf16_f32 v166, v164, v165
    v_cvt_pk_bf16_f32 v167, v156, -v157
    v_pk_mul_f32 v[162:163], v[164:165], v[152:153] op_sel_hi:[0,1]
    v_pk_mul_f32 v[158:159], v[156:157], v[148:149] op_sel_hi:[0,1]
    ds_write_addtid_b32 v166 offset:8160
    v_pk_fma_f32 v[162:163], v[164:165], v[152:153], v[162:163] op_sel:[1,1,0] op_sel_hi:[1,0,1] neg_lo:[1,0,0]
    v_pk_fma_f32 v[158:159], v[156:157], v[148:149], v[158:159] op_sel:[1,1,0] op_sel_hi:[1,0,1] neg_lo:[1,0,0]
    ds_write_addtid_b32 v167 offset:2176
    v_cvt_pk_bf16_f32 v168, v162, v163
    v_cvt_pk_bf16_f32 v169, v158, -v159
    v_pk_mul_f32 v[164:165], v[162:163], v[152:153] op_sel_hi:[0,1]
    v_pk_mul_f32 v[160:161], v[158:159], v[148:149] op_sel_hi:[0,1]
    ds_write_addtid_b32 v168 offset:8432
    v_pk_fma_f32 v[164:165], v[162:163], v[152:153], v[164:165] op_sel:[1,1,0] op_sel_hi:[1,0,1] neg_lo:[1,0,0]
    v_pk_fma_f32 v[160:161], v[158:159], v[148:149], v[160:161] op_sel:[1,1,0] op_sel_hi:[1,0,1] neg_lo:[1,0,0]
    ds_write_addtid_b32 v169 offset:2448
    v_cvt_pk_bf16_f32 v170, v164, v165
    v_cvt_pk_bf16_f32 v171, v160, -v161
    v_pk_mul_f32 v[162:163], v[164:165], v[152:153] op_sel_hi:[0,1]
    v_pk_mul_f32 v[158:159], v[160:161], v[148:149] op_sel_hi:[0,1]
    ds_write_addtid_b32 v170 offset:8704
    v_pk_fma_f32 v[162:163], v[164:165], v[152:153], v[162:163] op_sel:[1,1,0] op_sel_hi:[1,0,1] neg_lo:[1,0,0]
    v_pk_fma_f32 v[158:159], v[160:161], v[148:149], v[158:159] op_sel:[1,1,0] op_sel_hi:[1,0,1] neg_lo:[1,0,0]
    ds_write_addtid_b32 v171 offset:2720
    v_cvt_pk_bf16_f32 v172, v162, v163
    v_cvt_pk_bf16_f32 v173, v158, -v159
    v_pk_mul_f32 v[164:165], v[162:163], v[152:153] op_sel_hi:[0,1]
    v_pk_mul_f32 v[14:15], v[156:157], v[154:155] op_sel_hi:[0,1]
    ds_write_addtid_b32 v172 offset:8976
    v_pk_fma_f32 v[164:165], v[162:163], v[152:153], v[164:165] op_sel:[1,1,0] op_sel_hi:[1,0,1] neg_lo:[1,0,0]
    v_pk_fma_f32 v[156:157], v[156:157], v[154:155], v[14:15] op_sel:[1,1,0] op_sel_hi:[1,0,1] neg_lo:[1,0,0]
    ds_write_addtid_b32 v173 offset:2992
    v_cvt_pk_bf16_f32 v166, v164, v165
    v_cvt_pk_bf16_f32 v167, v156, -v157
    v_pk_mul_f32 v[162:163], v[164:165], v[152:153] op_sel_hi:[0,1]
    v_pk_mul_f32 v[158:159], v[156:157], v[150:151] op_sel_hi:[0,1]
    ds_write_addtid_b32 v166 offset:9248
    v_pk_fma_f32 v[162:163], v[164:165], v[152:153], v[162:163] op_sel:[1,1,0] op_sel_hi:[1,0,1] neg_lo:[1,0,0]
    v_pk_fma_f32 v[158:159], v[156:157], v[150:151], v[158:159] op_sel:[1,1,0] op_sel_hi:[1,0,1] neg_lo:[1,0,0]
    ds_write_addtid_b32 v167 offset:3264
    v_cvt_pk_bf16_f32 v168, v162, v163
    v_cvt_pk_bf16_f32 v169, v158, -v159
    v_pk_mul_f32 v[164:165], v[162:163], v[152:153] op_sel_hi:[0,1]
    v_pk_mul_f32 v[14:15], v[156:157], v[154:155] op_sel_hi:[0,1]
    ds_write_addtid_b32 v168 offset:9520
    v_pk_fma_f32 v[164:165], v[162:163], v[152:153], v[164:165] op_sel:[1,1,0] op_sel_hi:[1,0,1] neg_lo:[1,0,0]
    v_pk_fma_f32 v[156:157], v[156:157], v[154:155], v[14:15] op_sel:[1,1,0] op_sel_hi:[1,0,1] neg_lo:[1,0,0]
    ds_write_addtid_b32 v169 offset:3536
    v_cvt_pk_bf16_f32 v170, v164, v165
    v_cvt_pk_bf16_f32 v171, v156, -v157
    v_pk_mul_f32 v[162:163], v[164:165], v[152:153] op_sel_hi:[0,1]
    v_pk_mul_f32 v[158:159], v[156:157], v[150:151] op_sel_hi:[0,1]
    ds_write_addtid_b32 v170 offset:9792
    v_pk_fma_f32 v[162:163], v[164:165], v[152:153], v[162:163] op_sel:[1,1,0] op_sel_hi:[1,0,1] neg_lo:[1,0,0]
    v_pk_fma_f32 v[158:159], v[156:157], v[150:151], v[158:159] op_sel:[1,1,0] op_sel_hi:[1,0,1] neg_lo:[1,0,0]
    ds_write_addtid_b32 v171 offset:3808
    v_cvt_pk_bf16_f32 v172, v162, v163
    v_cvt_pk_bf16_f32 v173, v158, -v159
    v_pk_mul_f32 v[164:165], v[162:163], v[152:153] op_sel_hi:[0,1]
    v_pk_mul_f32 v[14:15], v[156:157], v[154:155] op_sel_hi:[0,1]
    ds_write_addtid_b32 v172 offset:10064
    v_pk_fma_f32 v[164:165], v[162:163], v[152:153], v[164:165] op_sel:[1,1,0] op_sel_hi:[1,0,1] neg_lo:[1,0,0]
    v_pk_fma_f32 v[156:157], v[156:157], v[154:155], v[14:15] op_sel:[1,1,0] op_sel_hi:[1,0,1] neg_lo:[1,0,0]
    ds_write_addtid_b32 v173 offset:4080
    v_cvt_pk_bf16_f32 v166, v164, v165
    v_cvt_pk_bf16_f32 v167, v156, -v157
    v_pk_mul_f32 v[162:163], v[164:165], v[152:153] op_sel_hi:[0,1]
    v_pk_mul_f32 v[14:15], v[156:157], v[154:155] op_sel_hi:[0,1]
    ds_write_addtid_b32 v166 offset:10336
    v_pk_fma_f32 v[162:163], v[164:165], v[152:153], v[162:163] op_sel:[1,1,0] op_sel_hi:[1,0,1] neg_lo:[1,0,0]
    v_pk_fma_f32 v[156:157], v[156:157], v[154:155], v[14:15] op_sel:[1,1,0] op_sel_hi:[1,0,1] neg_lo:[1,0,0]
    ds_write_addtid_b32 v167 offset:4352
    v_cvt_pk_bf16_f32 v168, v162, v163
    v_cvt_pk_bf16_f32 v169, v156, -v157
    v_pk_mul_f32 v[164:165], v[162:163], v[152:153] op_sel_hi:[0,1]
    v_pk_mul_f32 v[14:15], v[156:157], v[154:155] op_sel_hi:[0,1]
    ds_write_addtid_b32 v168 offset:10608
    v_pk_fma_f32 v[164:165], v[162:163], v[152:153], v[164:165] op_sel:[1,1,0] op_sel_hi:[1,0,1] neg_lo:[1,0,0]
    v_pk_fma_f32 v[156:157], v[156:157], v[154:155], v[14:15] op_sel:[1,1,0] op_sel_hi:[1,0,1] neg_lo:[1,0,0]
    ds_write_addtid_b32 v169 offset:4624
    v_cvt_pk_bf16_f32 v170, v164, v165
    v_cvt_pk_bf16_f32 v171, v156, -v157
    v_pk_mul_f32 v[162:163], v[164:165], v[152:153] op_sel_hi:[0,1]
    v_pk_mul_f32 v[14:15], v[156:157], v[154:155] op_sel_hi:[0,1]
    ds_write_addtid_b32 v170 offset:10880
    v_pk_fma_f32 v[162:163], v[164:165], v[152:153], v[162:163] op_sel:[1,1,0] op_sel_hi:[1,0,1] neg_lo:[1,0,0]
    v_pk_fma_f32 v[156:157], v[156:157], v[154:155], v[14:15] op_sel:[1,1,0] op_sel_hi:[1,0,1] neg_lo:[1,0,0]
    ds_write_addtid_b32 v171 offset:4896
    v_cvt_pk_bf16_f32 v172, v162, v163
    v_cvt_pk_bf16_f32 v173, v156, -v157
    v_pk_mul_f32 v[164:165], v[162:163], v[152:153] op_sel_hi:[0,1]
    v_pk_mul_f32 v[14:15], v[156:157], v[154:155] op_sel_hi:[0,1]
    ds_write_addtid_b32 v172 offset:11152
    v_pk_fma_f32 v[164:165], v[162:163], v[152:153], v[164:165] op_sel:[1,1,0] op_sel_hi:[1,0,1] neg_lo:[1,0,0]
    v_pk_fma_f32 v[156:157], v[156:157], v[154:155], v[14:15] op_sel:[1,1,0] op_sel_hi:[1,0,1] neg_lo:[1,0,0]
    ds_write_addtid_b32 v173 offset:5168
    v_cvt_pk_bf16_f32 v166, v164, v165
    v_cvt_pk_bf16_f32 v167, v156, -v157
    v_pk_mul_f32 v[148:149], v[152:153], v[152:153] op_sel_hi:[0,1]
    ds_write_addtid_b32 v166 offset:11424
    v_pk_fma_f32 v[148:149], v[152:153], v[152:153], v[148:149] op_sel:[1,1,0] op_sel_hi:[1,0,1] neg_lo:[1,0,0]
    ds_write_addtid_b32 v167 offset:5440
    v_pk_mul_f32 v[146:147], v[162:163], v[148:149] op_sel_hi:[0,1]
    v_pk_mul_f32 v[150:151], v[164:165], v[148:149] op_sel_hi:[0,1]
    v_pk_fma_f32 v[146:147], v[162:163], v[148:149], v[146:147] op_sel:[1,1,0] op_sel_hi:[1,0,1] neg_lo:[1,0,0]
    v_pk_fma_f32 v[150:151], v[164:165], v[148:149], v[150:151] op_sel:[1,1,0] op_sel_hi:[1,0,1] neg_lo:[1,0,0]
    v_cvt_pk_bf16_f32 v168, v146, v147
    v_cvt_pk_bf16_f32 v169, v150, v151
    v_pk_mul_f32 v[158:159], v[146:147], v[148:149] op_sel_hi:[0,1]
    v_pk_mul_f32 v[160:161], v[150:151], v[148:149] op_sel_hi:[0,1]
    ds_write_addtid_b32 v168 offset:11696
    v_pk_fma_f32 v[158:159], v[146:147], v[148:149], v[158:159] op_sel:[1,1,0] op_sel_hi:[1,0,1] neg_lo:[1,0,0]
    v_pk_fma_f32 v[160:161], v[150:151], v[148:149], v[160:161] op_sel:[1,1,0] op_sel_hi:[1,0,1] neg_lo:[1,0,0]
    ds_write_addtid_b32 v169 offset:11968
    v_cvt_pk_bf16_f32 v170, v158, v159
    v_cvt_pk_bf16_f32 v171, v160, v161
    v_pk_mul_f32 v[146:147], v[158:159], v[148:149] op_sel_hi:[0,1]
    v_pk_mul_f32 v[150:151], v[160:161], v[148:149] op_sel_hi:[0,1]
    ds_write_addtid_b32 v170 offset:12240
    v_pk_fma_f32 v[146:147], v[158:159], v[148:149], v[146:147] op_sel:[1,1,0] op_sel_hi:[1,0,1] neg_lo:[1,0,0]
    v_pk_fma_f32 v[150:151], v[160:161], v[148:149], v[150:151] op_sel:[1,1,0] op_sel_hi:[1,0,1] neg_lo:[1,0,0]
    ds_write_addtid_b32 v171 offset:12512
    v_cvt_pk_bf16_f32 v172, v146, v147
    v_cvt_pk_bf16_f32 v173, v150, v151
    v_pk_mul_f32 v[158:159], v[146:147], v[148:149] op_sel_hi:[0,1]
    v_pk_mul_f32 v[160:161], v[150:151], v[148:149] op_sel_hi:[0,1]
    ds_write_addtid_b32 v172 offset:12784
    v_pk_fma_f32 v[158:159], v[146:147], v[148:149], v[158:159] op_sel:[1,1,0] op_sel_hi:[1,0,1] neg_lo:[1,0,0]
    v_pk_fma_f32 v[160:161], v[150:151], v[148:149], v[160:161] op_sel:[1,1,0] op_sel_hi:[1,0,1] neg_lo:[1,0,0]
    ds_write_addtid_b32 v173 offset:13056
    v_cvt_pk_bf16_f32 v166, v158, v159
    v_cvt_pk_bf16_f32 v167, v160, v161
    v_pk_mul_f32 v[146:147], v[158:159], v[148:149] op_sel_hi:[0,1]
    v_pk_mul_f32 v[150:151], v[160:161], v[148:149] op_sel_hi:[0,1]
    ds_write_addtid_b32 v166 offset:13328
    v_pk_fma_f32 v[146:147], v[158:159], v[148:149], v[146:147] op_sel:[1,1,0] op_sel_hi:[1,0,1] neg_lo:[1,0,0]
    v_pk_fma_f32 v[150:151], v[160:161], v[148:149], v[150:151] op_sel:[1,1,0] op_sel_hi:[1,0,1] neg_lo:[1,0,0]
    ds_write_addtid_b32 v167 offset:13600
    v_cvt_pk_bf16_f32 v168, v146, v147
    v_cvt_pk_bf16_f32 v169, v150, v151
    ds_write_addtid_b32 v168 offset:13872
    ds_write_addtid_b32 v169 offset:14144
    s_cmp_lg_u32 s61, 0
    s_cbranch_scc1 L_last
    s_mov_b32 s61, 1
    s_nop 0
    ds_read_b128 v[64:67], v219 offset:0
    ds_read_b128 v[80:83], v220 offset:0
    ds_read_b128 v[68:71], v219 offset:32
    ds_read_b128 v[84:87], v220 offset:32
    ds_read_b128 v[72:75], v219 offset:64
    ds_read_b128 v[88:91], v220 offset:64
    v_and_b32 v8, s62, v200
    v_and_b32 v9, s62, v201
    v_and_b32 v10, s62, v202
    v_and_b32 v11, s62, v203
    v_and_b32 v12, s62, v204
    v_and_b32 v13, s62, v205
    ds_read_b128 v[76:79], v219 offset:96
    ds_read_b128 v[92:95], v220 offset:96
    s_waitcnt lgkmcnt(6)
    s_nop 0
    v_mfma_f32_32x32x16_bf16 v[176:191], v[64:67], v[80:83], 0
    v_mul_f32 v8, s66, v8
    v_mul_f32 v9, s66, v9
    v_mul_f32 v140, 0x3fb8aa3b, v8
    ds_read_b128 v[64:67], v219 offset:128
    ds_read_b128 v[80:83], v220 offset:128
    s_waitcnt lgkmcnt(6)
    s_nop 0
    v_mfma_f32_32x32x16_bf16 v[176:191], v[68:71], v[84:87], v[176:191]
    v_mul_f32_e64 v141, s69, v9
    v_fma_f32 v142, v9, s69, -v141
    v_fmac_f32 v142, 0x31dc9c88, v9
    ds_read_b128 v[68:71], v219 offset:160
    ds_read_b128 v[84:87], v220 offset:160
    s_waitcnt lgkmcnt(6)
    s_nop 0
    v_mfma_f32_32x32x16_bf16 v[176:191], v[72:75], v[88:91], v[176:191]
    v_exp_f32 v136, v140
    v_fract_f32 v137, v141
    v_mul_f32 v138, 0x41000000, v140
    ds_read_b128 v[72:75], v219 offset:192
    ds_read_b128 v[88:91], v220 offset:192
    s_waitcnt lgkmcnt(6)
    s_nop 0
    v_mfma_f32_32x32x16_bf16 v[176:191], v[76:79], v[92:95], v[176:191]
    v_mul_f32 v139, 0x41000000, v141
    v_exp_f32 v138, v138
    v_fract_f32 v139, v139
    ds_read_b128 v[76:79], v219 offset:224
    ds_read_b128 v[92:95], v220 offset:224
    s_waitcnt lgkmcnt(6)
    s_nop 0
    v_mfma_f32_32x32x16_bf16 v[176:191], v[64:67], v[80:83], v[176:191]
    v_mul_f32 v144, 0x43800000, v140
    v_mul_f32 v145, 0x43800000, v141
    v_exp_f32 v144, v144
    s_waitcnt lgkmcnt(4)
    v_mfma_f32_32x32x16_bf16 v[176:191], v[68:71], v[84:87], v[176:191]
    v_fract_f32 v145, v145
    v_add_f32 v137, v137, v142
    v_fmac_f32 v139, 0x41000000, v142
    v_fmac_f32 v145, 0x43800000, v142
    s_waitcnt lgkmcnt(2)
    s_nop 0
    v_mfma_f32_32x32x16_bf16 v[176:191], v[72:75], v[88:91], v[176:191]
    v_cos_f32 v146, v137
    v_sin_f32 v147, v137
    v_cos_f32 v152, v139
    v_sin_f32 v153, v139
    s_waitcnt lgkmcnt(0)
    s_nop 0
    v_mfma_f32_32x32x16_bf16 v[176:191], v[76:79], v[92:95], v[176:191]
    v_cos_f32 v154, v145
    v_sin_f32 v155, v145
    s_branch L_round
L_last:
    s_nop 0
    ds_read_b128 v[64:67], v219 offset:0
    ds_read_b128 v[80:83], v220 offset:0
    ds_read_b128 v[68:71], v219 offset:32
    ds_read_b128 v[84:87], v220 offset:32
    ds_read_b128 v[72:75], v219 offset:64
    ds_read_b128 v[88:91], v220 offset:64
    s_mul_i32 s11, s54, 14416
    s_add_u32 s11, s11, 256
    v_and_b32 v13, 31, v1
    v_lshrrev_b32 v14, 5, v1
    v_lshlrev_b32_e64 v15, 5, v13
    v_lshl_add_u32 v15, v14, 4, v15
    v_add_u32 v214, s11, v15
    v_cmp_eq_u32 vcc, 0, v14
    v_lshlrev_b32_e64 v15, 4, v13
    v_add_u32 v15, 1024, v15
    v_lshlrev_b32_e64 v12, 3, v13
    v_add_u32 v12, 1536, v12
    v_cndmask_b32 v11, v12, v15, vcc
    v_add_u32 v215, s11, v11
    ds_read_b128 v[76:79], v219 offset:96
    ds_read_b128 v[92:95], v220 offset:96
    s_waitcnt lgkmcnt(6)
    s_nop 0
    v_mfma_f32_32x32x16_bf16 v[176:191], v[64:67], v[80:83], v[176:191]
    v_add_u32_e64 v15, 8, v15
    v_add_u32 v12, 256, v12
    v_cndmask_b32 v11, v12, v15, vcc
    v_add_u32 v216, s11, v11
    v_lshlrev_b32_e64 v15, 2, v13
    v_lshl_add_u32 v15, v14, 9, v15
    ds_read_b128 v[64:67], v219 offset:128
    ds_read_b128 v[80:83], v220 offset:128
    s_waitcnt lgkmcnt(6)
    s_nop 0
    v_mfma_f32_32x32x16_bf16 v[176:191], v[68:71], v[84:87], v[176:191]
    v_add_u32 v15, 2048, v15
    v_add_u32 v217, s11, v15
    s_lshl_b32 s14, s54, 2
    s_add_u32 s14, s14, 0
    v_mov_b32 v226, s14
    v_and_b32_e64 v13, 3, v1
    ds_read_b128 v[68:71], v219 offset:160
    ds_read_b128 v[84:87], v220 offset:160
    s_waitcnt lgkmcnt(6)
    s_nop 0
    v_mfma_f32_32x32x16_bf16 v[176:191], v[72:75], v[88:91], v[176:191]
    v_lshlrev_b32 v13, 2, v13
    v_add_u32 v228, 0, v13
    v_mov_b32_e64 v229, 1
    s_mul_i32 s13, s54, 4160
    s_add_u32 s13, s13, 57952
    v_lshl_add_u32 v236, v1, 3, s13
    ds_read_b128 v[72:75], v219 offset:192
    ds_read_b128 v[88:91], v220 offset:192
    s_waitcnt lgkmcnt(6)
    s_nop 0
    v_mfma_f32_32x32x16_bf16 v[176:191], v[76:79], v[92:95], v[176:191]
    v_lshl_add_u32 v237, v1, 4, s13
    v_lshl_add_u32 v238, v1, 5, s13
    v_mov_b32 v8, 0
    v_mov_b32 v9, 0
    v_mov_b32 v10, 0
    v_mov_b32 v11, 0
    ds_read_b128 v[76:79], v219 offset:224
    ds_read_b128 v[92:95], v220 offset:224
    s_waitcnt lgkmcnt(6)
    s_nop 0
    v_mfma_f32_32x32x16_bf16 v[176:191], v[64:67], v[80:83], v[176:191]
    s_sub_u32 s14, s13, 32
    v_and_b32 v6, 1, v1
    v_lshl_add_u32 v6, v6, 4, s14
    ds_write_b128 v6, v[8:11]
    s_mul_i32 s14, s60, 28832
    s_add_u32 s14, s14, 256
    s_waitcnt lgkmcnt(5)
    s_nop 0
    v_mfma_f32_32x32x16_bf16 v[176:191], v[68:71], v[84:87], v[176:191]
    v_lshl_add_u32 v234, v1, 3, s14
    v_lshl_add_u32 v235, v1, 4, s14
    v_and_b32_e64 v6, 3, v1
    v_bfe_u32 v7, v1, 2, 2
    v_lshrrev_b32 v12, 4, v1
    v_add_u32 v13, v6, v7
    v_lshlrev_b32_e64 v13, 3, v13
    v_lshl_add_u32 v13, v12, 6, v13
    s_waitcnt lgkmcnt(3)
    s_nop 0
    v_mfma_f32_32x32x16_bf16 v[176:191], v[72:75], v[88:91], v[176:191]
    s_sub_u32 s14, s13, 24
    v_add_u32 v2, s14, v13
    v_mul_u32_u24 v14, 1088, v6
    v_lshl_add_u32 v14, v12, 4, v14
    v_lshlrev_b32 v13, 3, v7
    v_sub_u32 v14, v14, v13
    s_mul_i32 s15, s54, 4352
    s_add_u32 s14, s15, 74584
    s_waitcnt lgkmcnt(1)
    s_nop 0
    v_mfma_f32_32x32x16_bf16 v[176:191], v[76:79], v[92:95], v[176:191]
    v_add_u32_e64 v3, s14, v14
    v_mul_u32_u24 v14, 1088, v7
    v_lshl_add_u32 v14, v6, 4, v14
    s_add_u32 s14, s15, 75584
    v_add_u32_e64 v14, s14, v14
    ds_write_b128 v14, v[8:11]
    s_lshl_b32 s14, s54, 13
    s_nop 0
    s_add_u32 s14, s14, 100160
    v_lshl_add_u32 v4, v1, 2, s14
    s_lshl_b32 s14, s54, 2
    s_nop 0
    s_add_u32 s14, s14, 160
    v_mov_b32 v5, s14
    v_cmp_eq_u32 vcc, 0, v1
    v_mov_b32 v7, s67
    s_nop 0
    v_cndmask_b32 v239, 0, v7, vcc
    v_add_f32 v176, v176, v239
    ds_write_b128 v214, v[176:179]
    ds_write_b64 v215, v[180:181]
    ds_write_b64 v216, v[182:183]
    ds_write_b32 v217, v184 offset:0
    ds_write_b32 v217, v185 offset:128
    ds_write_b32 v217, v186 offset:256
    ds_write_b32 v217, v187 offset:384
    ds_write_b32 v226, v229 offset:128
    s_cmp_lt_u32 s54, 2
    s_cbranch_scc1 L_aunit
    s_mov_b32 s65, 0
L_w1:
    s_nop 0
    ds_read_b32 v7, v228 offset:192
    s_waitcnt lgkmcnt(0)
    v_cmp_ne_u32 vcc, 1, v7
    s_cbranch_vccz L_w1_ok
    s_add_u32 s65, s65, 1
    s_bitcmp0_b32 s65, 19
    s_cbranch_scc1 L_w1
L_w1_ok:
    s_branch L_kop
L_aunit:
    s_mov_b32 s65, 0
L_w2:
    ds_read_b32 v7, v228 offset:128
    s_waitcnt lgkmcnt(0)
    v_cmp_ne_u32 vcc, 1, v7
    s_cbranch_vccz L_w2_ok
    s_add_u32 s65, s65, 1
    s_bitcmp0_b32 s65, 19
    s_cbranch_scc1 L_w2
L_w2_ok:
    ds_read_b128 v[64:67], v235 offset:0
    ds_read_b128 v[68:71], v235 offset:14416
    ds_read_b64 v[72:73], v234 offset:1024
    ds_read_b32 v74, v234 offset:1032
    ds_read_b64 v[76:77], v234 offset:15440
    ds_read_b32 v78, v234 offset:15448
    ds_read_b64 v[80:81], v234 offset:1536
    ds_read_b32 v82, v234 offset:1544
    ds_read_b64 v[84:85], v234 offset:15952
    ds_read_b32 v86, v234 offset:15960
    ds_read_b64 v[88:89], v234 offset:2048
    ds_read_b32 v90, v234 offset:2056
    ds_read_b64 v[92:93], v234 offset:16464
    ds_read_b32 v94, v234 offset:16472
    s_waitcnt lgkmcnt(12)
    v_add_f32 v64, v64, v68
    v_add_f32 v65, v65, v69
    v_add_f32 v66, v66, v70
    v_add_f32_e64 v67, v67, v71
    v_cvt_pk_bf16_f32 v128, v64, v65
    v_cvt_pk_bf16_f32 v129, v66, v67
    ds_write_b64 v236, v[128:129]
    s_waitcnt lgkmcnt(10)
    v_add_f32 v72, v72, v76
    v_add_f32 v73, v73, v77
    s_waitcnt lgkmcnt(9)
    v_add_f32_e64 v74, v74, v78
    v_cvt_pk_bf16_f32 v130, v72, v72
    v_cvt_pk_bf16_f32 v131, v73, v74
    ds_write_b64 v236, v[130:131] offset:512
    s_waitcnt lgkmcnt(7)
    v_add_f32 v80, v80, v84
    v_add_f32 v81, v81, v85
    s_waitcnt lgkmcnt(6)
    v_add_f32_e64 v82, v82, v86
    v_cvt_pk_bf16_f32 v132, v80, v80
    v_cvt_pk_bf16_f32 v133, v80, v81
    v_cvt_pk_bf16_f32 v134, v81, v81
    v_cvt_pk_bf16_f32 v135, v82, v82
    ds_write_b128 v237, v[132:135] offset:1024
    s_waitcnt lgkmcnt(4)
    v_add_f32 v88, v88, v92
    v_add_f32 v89, v89, v93
    s_waitcnt lgkmcnt(3)
    v_add_f32_e64 v90, v90, v94
    v_cvt_pk_bf16_f32 v136, v88, v88
    v_cvt_pk_bf16_f32 v137, v88, v88
    v_cvt_pk_bf16_f32 v138, v88, v89
    v_cvt_pk_bf16_f32 v139, v89, v89
    v_cvt_pk_bf16_f32 v140, v89, v89
    v_cvt_pk_bf16_f32 v141, v89, v89
    v_cvt_pk_bf16_f32 v142, v90, v90
    v_cvt_pk_bf16_f32 v143, v90, v90
    ds_write_b128 v238, v[136:139] offset:2048
    ds_write_b128 v238, v[140:143] offset:2064
L_kop:
    v_mov_b32_e64 v6, v228
    ds_read_b64_tr_b16 v[192:193], v2 offset:0
    ds_read_b64_tr_b16 v[194:195], v2 offset:32
    ds_read_b64_tr_b16 v[196:197], v2 offset:256
    ds_read_b64_tr_b16 v[198:199], v2 offset:288
    ds_read_b64_tr_b16 v[200:201], v2 offset:512
    ds_read_b64_tr_b16 v[202:203], v2 offset:544
    ds_read_b64_tr_b16 v[204:205], v2 offset:768
    ds_read_b64_tr_b16 v[206:207], v2 offset:800
    ds_read_b64_tr_b16 v[208:209], v2 offset:1024
    ds_read_b64_tr_b16 v[210:211], v2 offset:1056
    ds_read_b64_tr_b16 v[212:213], v2 offset:1280
    ds_read_b64_tr_b16 v[214:215], v2 offset:1312
    ds_read_b64_tr_b16 v[216:217], v2 offset:1536
    ds_read_b64_tr_b16 v[218:219], v2 offset:1568
    ds_read_b64_tr_b16 v[220:221], v2 offset:1792
    ds_read_b64_tr_b16 v[222:223], v2 offset:1824
    v_mov_b32 v58, 0
    v_mov_b32 v59, 0
    v_mov_b32 v60, 0
    s_mov_b32 s65, 0
L_u0:
    ds_read_b32 v7, v6 offset:0
    ds_read_b64 v[64:65], v3 offset:992
    ds_read_b64 v[66:67], v3 offset:1000
    ds_read_b64 v[68:69], v3 offset:960
    ds_read_b64 v[70:71], v3 offset:968
    ds_read_b64 v[72:73], v3 offset:928
    ds_read_b64 v[74:75], v3 offset:936
    s_waitcnt lgkmcnt(6)
    v_cmp_ne_u32 vcc, 1, v7
    s_cbranch_vccz L_u0_ok
    s_waitcnt lgkmcnt(0)
    s_add_u32 s65, s65, 1
    s_bitcmp0_b32 s65, 19
    s_cbranch_scc1 L_u0
L_u0_ok:
    s_waitcnt lgkmcnt(4)
    v_mfma_f32_16x16x32_bf16 v[24:27], v[64:67], v[192:195], 0
    ds_read_b64 v[76:77], v3 offset:896
    ds_read_b64 v[78:79], v3 offset:904
    s_waitcnt lgkmcnt(4)
    s_nop 0
    v_mfma_f32_16x16x32_bf16 v[28:31], v[68:71], v[192:195], 0
    ds_read_b64 v[80:81], v3 offset:864
    ds_read_b64 v[82:83], v3 offset:872
    s_waitcnt lgkmcnt(4)
    s_nop 0
    v_mfma_f32_16x16x32_bf16 v[32:35], v[64:67], v[196:199], 0
    ds_read_b64 v[84:85], v3 offset:832
    ds_read_b64 v[86:87], v3 offset:840
    v_mfma_f32_16x16x32_bf16 v[32:35], v[72:75], v[192:195], v[32:35]
    v_add_f32_dpp v8, v58, v26 wave_ror:1 row_mask:0xf bank_mask:0xf
    v_add_f32_dpp v8, v27, v26 wave_shr:1 row_mask:0xf bank_mask:0xf
    v_mfma_f32_16x16x32_bf16 v[36:39], v[68:71], v[196:199], 0
    ds_read_b32 v7, v6 offset:32
    ds_read_b64 v[88:89], v3 offset:800
    s_waitcnt lgkmcnt(6)
    s_nop 0
    v_mfma_f32_16x16x32_bf16 v[36:39], v[76:79], v[192:195], v[36:39]
    ds_read_b64 v[90:91], v3 offset:808
    v_add_f32_dpp v9, v59, v25 wave_ror:1 row_mask:0xf bank_mask:0xf
    v_mfma_f32_16x16x32_bf16 v[40:43], v[64:67], v[200:203], 0
    ds_read_b64 v[92:93], v3 offset:768
    ds_read_b64 v[94:95], v3 offset:776
    v_mfma_f32_16x16x32_bf16 v[40:43], v[72:75], v[196:199], v[40:43]
    v_add_f32_dpp v9, v8, v25 wave_shr:1 row_mask:0xf bank_mask:0xf
    v_add_f32_dpp v10, v60, v24 wave_ror:1 row_mask:0xf bank_mask:0xf
    s_waitcnt lgkmcnt(7)
    s_nop 0
    v_mfma_f32_16x16x32_bf16 v[40:43], v[80:83], v[192:195], v[40:43]
    v_add_f32_dpp v10, v9, v24 wave_shr:1 row_mask:0xf bank_mask:0xf
    v_add_f32_dpp v12, v27, v30 wave_ror:1 row_mask:0xf bank_mask:0xf
    s_waitcnt lgkmcnt(4)
    v_cmp_ne_u32 vcc, 1, v7
    s_cbranch_vccnz L_us1
L_ub1:
    s_nop 0
    v_mfma_f32_16x16x32_bf16 v[44:47], v[68:71], v[200:203], 0
    ds_read_b64 v[96:97], v3 offset:736
    ds_read_b64 v[98:99], v3 offset:744
    v_mfma_f32_16x16x32_bf16 v[44:47], v[76:79], v[196:199], v[44:47]
    ds_write_b32 v4, v10 offset:0
    v_mfma_f32_16x16x32_bf16 v[44:47], v[84:87], v[192:195], v[44:47]
    v_add_f32_dpp v12, v31, v30 wave_shr:1 row_mask:0xf bank_mask:0xf
    v_add_f32_dpp v13, v8, v29 wave_ror:1 row_mask:0xf bank_mask:0xf
    v_mfma_f32_16x16x32_bf16 v[48:51], v[64:67], v[204:207], 0
    ds_read_b64 v[100:101], v3 offset:704
    ds_read_b64 v[102:103], v3 offset:712
    v_mfma_f32_16x16x32_bf16 v[48:51], v[72:75], v[200:203], v[48:51]
    v_add_f32_dpp v13, v12, v29 wave_shr:1 row_mask:0xf bank_mask:0xf
    v_add_f32_dpp v14, v9, v28 wave_ror:1 row_mask:0xf bank_mask:0xf
    v_mfma_f32_16x16x32_bf16 v[48:51], v[80:83], v[196:199], v[48:51]
    v_add_f32_dpp v14, v13, v28 wave_shr:1 row_mask:0xf bank_mask:0xf
    v_mov_b32_e64 v61, 2
    s_waitcnt lgkmcnt(7)
    s_nop 0
    v_mfma_f32_16x16x32_bf16 v[48:51], v[88:91], v[192:195], v[48:51]
    ds_write_b32 v4, v14 offset:256
    v_mfma_f32_16x16x32_bf16 v[52:55], v[68:71], v[204:207], 0
    ds_read_b64 v[104:105], v3 offset:672
    ds_read_b64 v[106:107], v3 offset:680
    v_mfma_f32_16x16x32_bf16 v[52:55], v[76:79], v[200:203], v[52:55]
    ds_write_b32 v5, v61
    v_mfma_f32_16x16x32_bf16 v[52:55], v[84:87], v[196:199], v[52:55]
    v_add_f32_dpp v16, v31, v34 wave_ror:1 row_mask:0xf bank_mask:0xf
    v_add_f32_dpp v16, v35, v34 wave_shr:1 row_mask:0xf bank_mask:0xf
    s_waitcnt lgkmcnt(9)
    s_nop 0
    v_mfma_f32_16x16x32_bf16 v[52:55], v[92:95], v[192:195], v[52:55]
    v_add_f32_dpp v17, v12, v33 wave_ror:1 row_mask:0xf bank_mask:0xf
    v_add_f32_dpp v17, v16, v33 wave_shr:1 row_mask:0xf bank_mask:0xf
    v_mfma_f32_16x16x32_bf16 v[24:27], v[64:67], v[208:211], 0
    ds_read_b64 v[108:109], v3 offset:640
    ds_read_b64 v[110:111], v3 offset:648
    v_mfma_f32_16x16x32_bf16 v[24:27], v[72:75], v[204:207], v[24:27]
    v_add_f32_dpp v18, v13, v32 wave_ror:1 row_mask:0xf bank_mask:0xf
    v_add_f32_dpp v18, v17, v32 wave_shr:1 row_mask:0xf bank_mask:0xf
    v_mfma_f32_16x16x32_bf16 v[24:27], v[80:83], v[200:203], v[24:27]
    ds_write_b32 v4, v18 offset:512
    v_mfma_f32_16x16x32_bf16 v[24:27], v[88:91], v[196:199], v[24:27]
    v_add_f32_dpp v20, v35, v38 wave_ror:1 row_mask:0xf bank_mask:0xf
    v_add_f32_dpp v20, v39, v38 wave_shr:1 row_mask:0xf bank_mask:0xf
    s_waitcnt lgkmcnt(10)
    s_nop 0
    v_mfma_f32_16x16x32_bf16 v[24:27], v[96:99], v[192:195], v[24:27]
    v_add_f32_dpp v21, v16, v37 wave_ror:1 row_mask:0xf bank_mask:0xf
    v_add_f32_dpp v21, v20, v37 wave_shr:1 row_mask:0xf bank_mask:0xf
    v_mfma_f32_16x16x32_bf16 v[28:31], v[68:71], v[208:211], 0
    ds_read_b64 v[112:113], v3 offset:608
    ds_read_b64 v[114:115], v3 offset:616
    v_mfma_f32_16x16x32_bf16 v[28:31], v[76:79], v[204:207], v[28:31]
    v_add_f32_dpp v22, v17, v36 wave_ror:1 row_mask:0xf bank_mask:0xf
    v_add_f32_dpp v22, v21, v36 wave_shr:1 row_mask:0xf bank_mask:0xf
    v_mfma_f32_16x16x32_bf16 v[28:31], v[84:87], v[200:203], v[28:31]
    ds_write_b32 v4, v22 offset:768
    v_mfma_f32_16x16x32_bf16 v[28:31], v[92:95], v[196:199], v[28:31]
    v_mov_b32_e64 v61, 4
    v_add_f32_dpp v8, v39, v42 wave_ror:1 row_mask:0xf bank_mask:0xf
    s_waitcnt lgkmcnt(10)
    s_nop 0
    v_mfma_f32_16x16x32_bf16 v[28:31], v[100:103], v[192:195], v[28:31]
    ds_write_b32 v5, v61
    v_mfma_f32_16x16x32_bf16 v[32:35], v[64:67], v[212:215], 0
    ds_read_b64 v[116:117], v3 offset:576
    ds_read_b64 v[118:119], v3 offset:584
    v_mfma_f32_16x16x32_bf16 v[32:35], v[72:75], v[208:211], v[32:35]
    v_add_f32_dpp v8, v43, v42 wave_shr:1 row_mask:0xf bank_mask:0xf
    v_add_f32_dpp v9, v20, v41 wave_ror:1 row_mask:0xf bank_mask:0xf
    v_mfma_f32_16x16x32_bf16 v[32:35], v[80:83], v[204:207], v[32:35]
    v_add_f32_dpp v9, v8, v41 wave_shr:1 row_mask:0xf bank_mask:0xf
    v_add_f32_dpp v10, v21, v40 wave_ror:1 row_mask:0xf bank_mask:0xf
    v_mfma_f32_16x16x32_bf16 v[32:35], v[88:91], v[200:203], v[32:35]
    v_add_f32_dpp v10, v9, v40 wave_shr:1 row_mask:0xf bank_mask:0xf
    v_add_f32_dpp v12, v43, v46 wave_ror:1 row_mask:0xf bank_mask:0xf
    v_mfma_f32_16x16x32_bf16 v[32:35], v[96:99], v[196:199], v[32:35]
    ds_write_b32 v4, v10 offset:1024
    s_waitcnt lgkmcnt(11)
    s_nop 0
    v_mfma_f32_16x16x32_bf16 v[32:35], v[104:107], v[192:195], v[32:35]
    v_add_f32_dpp v12, v47, v46 wave_shr:1 row_mask:0xf bank_mask:0xf
    v_add_f32_dpp v13, v8, v45 wave_ror:1 row_mask:0xf bank_mask:0xf
    v_mfma_f32_16x16x32_bf16 v[36:39], v[68:71], v[212:215], 0
    ds_read_b32 v7, v6 offset:64
    ds_read_b64 v[120:121], v3 offset:544
    v_mfma_f32_16x16x32_bf16 v[36:39], v[76:79], v[208:211], v[36:39]
    ds_read_b64 v[122:123], v3 offset:552
    v_add_f32_dpp v13, v12, v45 wave_shr:1 row_mask:0xf bank_mask:0xf
    v_mfma_f32_16x16x32_bf16 v[36:39], v[84:87], v[204:207], v[36:39]
    v_add_f32_dpp v14, v9, v44 wave_ror:1 row_mask:0xf bank_mask:0xf
    v_add_f32_dpp v14, v13, v44 wave_shr:1 row_mask:0xf bank_mask:0xf
    v_mfma_f32_16x16x32_bf16 v[36:39], v[92:95], v[200:203], v[36:39]
    ds_write_b32 v4, v14 offset:1280
    v_mfma_f32_16x16x32_bf16 v[36:39], v[100:103], v[196:199], v[36:39]
    v_mov_b32_e64 v61, 6
    v_add_f32_dpp v16, v47, v50 wave_ror:1 row_mask:0xf bank_mask:0xf
    s_waitcnt lgkmcnt(12)
    s_nop 0
    v_mfma_f32_16x16x32_bf16 v[36:39], v[108:111], v[192:195], v[36:39]
    ds_write_b32 v5, v61
    v_mfma_f32_16x16x32_bf16 v[40:43], v[64:67], v[216:219], 0
    ds_read_b64 v[124:125], v3 offset:512
    ds_read_b64 v[126:127], v3 offset:520
    v_mfma_f32_16x16x32_bf16 v[40:43], v[72:75], v[212:215], v[40:43]
    ds_read_b64_tr_b16 v[224:225], v2 offset:2048
    ds_read_b64_tr_b16 v[226:227], v2 offset:2080
    v_mfma_f32_16x16x32_bf16 v[40:43], v[80:83], v[208:211], v[40:43]
    v_add_f32_dpp v16, v51, v50 wave_shr:1 row_mask:0xf bank_mask:0xf
    v_add_f32_dpp v17, v12, v49 wave_ror:1 row_mask:0xf bank_mask:0xf
    v_mfma_f32_16x16x32_bf16 v[40:43], v[88:91], v[204:207], v[40:43]
    v_add_f32_dpp v17, v16, v49 wave_shr:1 row_mask:0xf bank_mask:0xf
    v_add_f32_dpp v18, v13, v48 wave_ror:1 row_mask:0xf bank_mask:0xf
    v_mfma_f32_16x16x32_bf16 v[40:43], v[96:99], v[200:203], v[40:43]
    v_add_f32_dpp v18, v17, v48 wave_shr:1 row_mask:0xf bank_mask:0xf
    v_add_f32_dpp v20, v51, v54 wave_ror:1 row_mask:0xf bank_mask:0xf
    v_mfma_f32_16x16x32_bf16 v[40:43], v[104:107], v[196:199], v[40:43]
    ds_write_b32 v4, v18 offset:1536
    s_waitcnt lgkmcnt(15)
    s_nop 0
    v_mfma_f32_16x16x32_bf16 v[40:43], v[112:115], v[192:195], v[40:43]
    v_add_f32_dpp v20, v55, v54 wave_shr:1 row_mask:0xf bank_mask:0xf
    v_add_f32_dpp v21, v16, v53 wave_ror:1 row_mask:0xf bank_mask:0xf
    s_waitcnt lgkmcnt(9)
    v_cmp_ne_u32 vcc, 1, v7
    s_cbranch_vccnz L_us2
L_ub2:
    s_nop 0
    v_mfma_f32_16x16x32_bf16 v[44:47], v[68:71], v[216:219], 0
    ds_read_b64 v[128:129], v3 offset:480
    ds_read_b64 v[130:131], v3 offset:488
    v_mfma_f32_16x16x32_bf16 v[44:47], v[76:79], v[212:215], v[44:47]
    v_add_f32_dpp v21, v20, v53 wave_shr:1 row_mask:0xf bank_mask:0xf
    v_add_f32_dpp v22, v17, v52 wave_ror:1 row_mask:0xf bank_mask:0xf
    v_mfma_f32_16x16x32_bf16 v[44:47], v[84:87], v[208:211], v[44:47]
    v_add_f32_dpp v22, v21, v52 wave_shr:1 row_mask:0xf bank_mask:0xf
    v_mov_b32_e64 v61, 8
    v_mfma_f32_16x16x32_bf16 v[44:47], v[92:95], v[204:207], v[44:47]
    ds_write_b32 v4, v22 offset:1792
    v_mfma_f32_16x16x32_bf16 v[44:47], v[100:103], v[200:203], v[44:47]
    ds_write_b32 v5, v61
    v_mfma_f32_16x16x32_bf16 v[44:47], v[108:111], v[196:199], v[44:47]
    v_add_f32_dpp v8, v55, v26 wave_ror:1 row_mask:0xf bank_mask:0xf
    v_add_f32_dpp v8, v27, v26 wave_shr:1 row_mask:0xf bank_mask:0xf
    v_mfma_f32_16x16x32_bf16 v[44:47], v[116:119], v[192:195], v[44:47]
    v_add_f32_dpp v9, v20, v25 wave_ror:1 row_mask:0xf bank_mask:0xf
    v_add_f32_dpp v9, v8, v25 wave_shr:1 row_mask:0xf bank_mask:0xf
    v_mfma_f32_16x16x32_bf16 v[48:51], v[64:67], v[220:223], 0
    ds_read_b64 v[132:133], v3 offset:448
    ds_read_b64 v[134:135], v3 offset:456
    v_mfma_f32_16x16x32_bf16 v[48:51], v[72:75], v[216:219], v[48:51]
    ds_read_b64_tr_b16 v[228:229], v2 offset:2304
    ds_read_b64_tr_b16 v[230:231], v2 offset:2336
    v_mfma_f32_16x16x32_bf16 v[48:51], v[80:83], v[212:215], v[48:51]
    v_add_f32_dpp v10, v21, v24 wave_ror:1 row_mask:0xf bank_mask:0xf
    v_add_f32_dpp v10, v9, v24 wave_shr:1 row_mask:0xf bank_mask:0xf
    v_mfma_f32_16x16x32_bf16 v[48:51], v[88:91], v[208:211], v[48:51]
    ds_write_b32 v4, v10 offset:2048
    v_mfma_f32_16x16x32_bf16 v[48:51], v[96:99], v[204:207], v[48:51]
    v_add_f32_dpp v12, v27, v30 wave_ror:1 row_mask:0xf bank_mask:0xf
    v_add_f32_dpp v12, v31, v30 wave_shr:1 row_mask:0xf bank_mask:0xf
    v_mfma_f32_16x16x32_bf16 v[48:51], v[104:107], v[200:203], v[48:51]
    v_add_f32_dpp v13, v8, v29 wave_ror:1 row_mask:0xf bank_mask:0xf
    v_add_f32_dpp v13, v12, v29 wave_shr:1 row_mask:0xf bank_mask:0xf
    v_mfma_f32_16x16x32_bf16 v[48:51], v[112:115], v[196:199], v[48:51]
    v_add_f32_dpp v14, v9, v28 wave_ror:1 row_mask:0xf bank_mask:0xf
    v_add_f32_dpp v14, v13, v28 wave_shr:1 row_mask:0xf bank_mask:0xf
    s_waitcnt lgkmcnt(15)
    s_nop 0
    v_mfma_f32_16x16x32_bf16 v[48:51], v[120:123], v[192:195], v[48:51]
    ds_write_b32 v4, v14 offset:2304
    v_mfma_f32_16x16x32_bf16 v[52:55], v[68:71], v[220:223], 0
    ds_read_b64 v[136:137], v3 offset:416
    ds_read_b64 v[138:139], v3 offset:424
    v_mfma_f32_16x16x32_bf16 v[52:55], v[76:79], v[216:219], v[52:55]
    v_mov_b32_e64 v61, 10
    v_add_f32_dpp v16, v31, v34 wave_ror:1 row_mask:0xf bank_mask:0xf
    v_mfma_f32_16x16x32_bf16 v[52:55], v[84:87], v[212:215], v[52:55]
    ds_write_b32 v5, v61
    v_mfma_f32_16x16x32_bf16 v[52:55], v[92:95], v[208:211], v[52:55]
    v_add_f32_dpp v16, v35, v34 wave_shr:1 row_mask:0xf bank_mask:0xf
    v_add_f32_dpp v17, v12, v33 wave_ror:1 row_mask:0xf bank_mask:0xf
    v_mfma_f32_16x16x32_bf16 v[52:55], v[100:103], v[204:207], v[52:55]
    v_add_f32_dpp v17, v16, v33 wave_shr:1 row_mask:0xf bank_mask:0xf
    v_add_f32_dpp v18, v13, v32 wave_ror:1 row_mask:0xf bank_mask:0xf
    v_mfma_f32_16x16x32_bf16 v[52:55], v[108:111], v[200:203], v[52:55]
    v_add_f32_dpp v18, v17, v32 wave_shr:1 row_mask:0xf bank_mask:0xf
    v_add_f32_dpp v20, v35, v38 wave_ror:1 row_mask:0xf bank_mask:0xf
    v_mfma_f32_16x16x32_bf16 v[52:55], v[116:119], v[196:199], v[52:55]
    ds_write_b32 v4, v18 offset:2560
    s_waitcnt lgkmcnt(15)
    s_nop 0
    v_mfma_f32_16x16x32_bf16 v[52:55], v[124:127], v[192:195], v[52:55]
    v_add_f32_dpp v20, v39, v38 wave_shr:1 row_mask:0xf bank_mask:0xf
    v_add_f32_dpp v21, v16, v37 wave_ror:1 row_mask:0xf bank_mask:0xf
    v_mfma_f32_16x16x32_bf16 v[24:27], v[64:67], v[224:227], 0
    ds_read_b64 v[140:141], v3 offset:384
    ds_read_b64 v[142:143], v3 offset:392
    v_mfma_f32_16x16x32_bf16 v[24:27], v[72:75], v[220:223], v[24:27]
    ds_read_b64_tr_b16 v[232:233], v2 offset:2560
    ds_read_b64_tr_b16 v[234:235], v2 offset:2592
    v_mfma_f32_16x16x32_bf16 v[24:27], v[80:83], v[216:219], v[24:27]
    v_add_f32_dpp v21, v20, v37 wave_shr:1 row_mask:0xf bank_mask:0xf
    v_add_f32_dpp v22, v17, v36 wave_ror:1 row_mask:0xf bank_mask:0xf
    v_mfma_f32_16x16x32_bf16 v[24:27], v[88:91], v[212:215], v[24:27]
    v_add_f32_dpp v22, v21, v36 wave_shr:1 row_mask:0xf bank_mask:0xf
    v_mov_b32_e64 v61, 12
    v_mfma_f32_16x16x32_bf16 v[24:27], v[96:99], v[208:211], v[24:27]
    ds_write_b32 v4, v22 offset:2816
    v_mfma_f32_16x16x32_bf16 v[24:27], v[104:107], v[204:207], v[24:27]
    ds_write_b32 v5, v61
    v_mfma_f32_16x16x32_bf16 v[24:27], v[112:115], v[200:203], v[24:27]
    v_add_f32_dpp v8, v39, v42 wave_ror:1 row_mask:0xf bank_mask:0xf
    v_add_f32_dpp v8, v43, v42 wave_shr:1 row_mask:0xf bank_mask:0xf
    v_mfma_f32_16x16x32_bf16 v[24:27], v[120:123], v[196:199], v[24:27]
    v_add_f32_dpp v9, v20, v41 wave_ror:1 row_mask:0xf bank_mask:0xf
    v_add_f32_dpp v9, v8, v41 wave_shr:1 row_mask:0xf bank_mask:0xf
    s_waitcnt lgkmcnt(15)
    s_nop 0
    v_mfma_f32_16x16x32_bf16 v[24:27], v[128:131], v[192:195], v[24:27]
    v_add_f32_dpp v10, v21, v40 wave_ror:1 row_mask:0xf bank_mask:0xf
    v_add_f32_dpp v10, v9, v40 wave_shr:1 row_mask:0xf bank_mask:0xf
    v_mfma_f32_16x16x32_bf16 v[28:31], v[68:71], v[224:227], 0
    ds_read_b64 v[144:145], v3 offset:352
    ds_read_b64 v[146:147], v3 offset:360
    v_mfma_f32_16x16x32_bf16 v[28:31], v[76:79], v[220:223], v[28:31]
    ds_write_b32 v4, v10 offset:3072
    v_mfma_f32_16x16x32_bf16 v[28:31], v[84:87], v[216:219], v[28:31]
    v_add_f32_dpp v12, v43, v46 wave_ror:1 row_mask:0xf bank_mask:0xf
    v_add_f32_dpp v12, v47, v46 wave_shr:1 row_mask:0xf bank_mask:0xf
    v_mfma_f32_16x16x32_bf16 v[28:31], v[92:95], v[212:215], v[28:31]
    v_add_f32_dpp v13, v8, v45 wave_ror:1 row_mask:0xf bank_mask:0xf
    v_add_f32_dpp v13, v12, v45 wave_shr:1 row_mask:0xf bank_mask:0xf
    v_mfma_f32_16x16x32_bf16 v[28:31], v[100:103], v[208:211], v[28:31]
    v_add_f32_dpp v14, v9, v44 wave_ror:1 row_mask:0xf bank_mask:0xf
    v_add_f32_dpp v14, v13, v44 wave_shr:1 row_mask:0xf bank_mask:0xf
    v_mfma_f32_16x16x32_bf16 v[28:31], v[108:111], v[204:207], v[28:31]
    ds_write_b32 v4, v14 offset:3328
    v_mfma_f32_16x16x32_bf16 v[28:31], v[116:119], v[200:203], v[28:31]
    v_mov_b32_e64 v61, 14
    v_add_f32_dpp v16, v47, v50 wave_ror:1 row_mask:0xf bank_mask:0xf
    v_mfma_f32_16x16x32_bf16 v[28:31], v[124:127], v[196:199], v[28:31]
    ds_write_b32 v5, v61
    s_waitcnt lgkmcnt(15)
    s_nop 0
    v_mfma_f32_16x16x32_bf16 v[28:31], v[132:135], v[192:195], v[28:31]
    v_add_f32_dpp v16, v51, v50 wave_shr:1 row_mask:0xf bank_mask:0xf
    v_add_f32_dpp v17, v12, v49 wave_ror:1 row_mask:0xf bank_mask:0xf
    v_mfma_f32_16x16x32_bf16 v[32:35], v[64:67], v[228:231], 0
    ds_read_b64 v[148:149], v3 offset:320
    ds_read_b64 v[150:151], v3 offset:328
    v_mfma_f32_16x16x32_bf16 v[32:35], v[72:75], v[224:227], v[32:35]
    ds_read_b64_tr_b16 v[236:237], v2 offset:2816
    ds_read_b64_tr_b16 v[238:239], v2 offset:2848
    v_mfma_f32_16x16x32_bf16 v[32:35], v[80:83], v[220:223], v[32:35]
    v_add_f32_dpp v17, v16, v49 wave_shr:1 row_mask:0xf bank_mask:0xf
    v_add_f32_dpp v18, v13, v48 wave_ror:1 row_mask:0xf bank_mask:0xf
    v_mfma_f32_16x16x32_bf16 v[32:35], v[88:91], v[216:219], v[32:35]
    v_add_f32_dpp v18, v17, v48 wave_shr:1 row_mask:0xf bank_mask:0xf
    v_add_f32_dpp v20, v51, v54 wave_ror:1 row_mask:0xf bank_mask:0xf
    v_mfma_f32_16x16x32_bf16 v[32:35], v[96:99], v[212:215], v[32:35]
    ds_write_b32 v4, v18 offset:3584
    v_mfma_f32_16x16x32_bf16 v[32:35], v[104:107], v[208:211], v[32:35]
    v_add_f32_dpp v20, v55, v54 wave_shr:1 row_mask:0xf bank_mask:0xf
    v_add_f32_dpp v21, v16, v53 wave_ror:1 row_mask:0xf bank_mask:0xf
    v_mfma_f32_16x16x32_bf16 v[32:35], v[112:115], v[204:207], v[32:35]
    v_add_f32_dpp v21, v20, v53 wave_shr:1 row_mask:0xf bank_mask:0xf
    v_add_f32_dpp v22, v17, v52 wave_ror:1 row_mask:0xf bank_mask:0xf
    v_mfma_f32_16x16x32_bf16 v[32:35], v[120:123], v[200:203], v[32:35]
    v_add_f32_dpp v22, v21, v52 wave_shr:1 row_mask:0xf bank_mask:0xf
    v_mov_b32_e64 v61, 16
    v_mfma_f32_16x16x32_bf16 v[32:35], v[128:131], v[196:199], v[32:35]
    ds_write_b32 v4, v22 offset:3840
    s_waitcnt lgkmcnt(15)
    s_nop 0
    v_mfma_f32_16x16x32_bf16 v[32:35], v[136:139], v[192:195], v[32:35]
    ds_write_b32 v5, v61
    v_mfma_f32_16x16x32_bf16 v[36:39], v[68:71], v[228:231], 0
    ds_read_b32 v7, v6 offset:96
    ds_read_b64 v[152:153], v3 offset:288
    v_mfma_f32_16x16x32_bf16 v[36:39], v[76:79], v[224:227], v[36:39]
    ds_read_b64 v[154:155], v3 offset:296
    v_add_f32_dpp v8, v55, v26 wave_ror:1 row_mask:0xf bank_mask:0xf
    v_mfma_f32_16x16x32_bf16 v[36:39], v[84:87], v[220:223], v[36:39]
    v_add_f32_dpp v8, v27, v26 wave_shr:1 row_mask:0xf bank_mask:0xf
    v_add_f32_dpp v9, v20, v25 wave_ror:1 row_mask:0xf bank_mask:0xf
    v_mfma_f32_16x16x32_bf16 v[36:39], v[92:95], v[216:219], v[36:39]
    v_add_f32_dpp v9, v8, v25 wave_shr:1 row_mask:0xf bank_mask:0xf
    v_add_f32_dpp v10, v21, v24 wave_ror:1 row_mask:0xf bank_mask:0xf
    v_mfma_f32_16x16x32_bf16 v[36:39], v[100:103], v[212:215], v[36:39]
    v_add_f32_dpp v10, v9, v24 wave_shr:1 row_mask:0xf bank_mask:0xf
    v_add_f32_dpp v12, v27, v30 wave_ror:1 row_mask:0xf bank_mask:0xf
    v_mfma_f32_16x16x32_bf16 v[36:39], v[108:111], v[208:211], v[36:39]
    ds_write_b32 v4, v10 offset:4096
    v_mfma_f32_16x16x32_bf16 v[36:39], v[116:119], v[204:207], v[36:39]
    v_add_f32_dpp v12, v31, v30 wave_shr:1 row_mask:0xf bank_mask:0xf
    v_add_f32_dpp v13, v8, v29 wave_ror:1 row_mask:0xf bank_mask:0xf
    v_mfma_f32_16x16x32_bf16 v[36:39], v[124:127], v[200:203], v[36:39]
    v_add_f32_dpp v13, v12, v29 wave_shr:1 row_mask:0xf bank_mask:0xf
    v_add_f32_dpp v14, v9, v28 wave_ror:1 row_mask:0xf bank_mask:0xf
    v_mfma_f32_16x16x32_bf16 v[36:39], v[132:135], v[196:199], v[36:39]
    v_add_f32_dpp v14, v13, v28 wave_shr:1 row_mask:0xf bank_mask:0xf
    v_mov_b32_e64 v61, 18
    v_mfma_f32_16x16x32_bf16 v[36:39], v[140:143], v[192:195], v[36:39]
    ds_write_b32 v4, v14 offset:4352
    s_waitcnt lgkmcnt(15)
    s_nop 0
    v_mfma_f32_16x16x32_bf16 v[40:43], v[64:67], v[232:235], 0
    ds_read_b64 v[156:157], v3 offset:256
    ds_read_b64 v[158:159], v3 offset:264
    v_mfma_f32_16x16x32_bf16 v[40:43], v[72:75], v[228:231], v[40:43]
    ds_read_b64_tr_b16 v[240:241], v2 offset:3072
    ds_read_b64_tr_b16 v[242:243], v2 offset:3104
    v_mfma_f32_16x16x32_bf16 v[40:43], v[80:83], v[224:227], v[40:43]
    ds_write_b32 v5, v61
    v_mfma_f32_16x16x32_bf16 v[40:43], v[88:91], v[220:223], v[40:43]
    v_add_f32_dpp v16, v31, v34 wave_ror:1 row_mask:0xf bank_mask:0xf
    v_add_f32_dpp v16, v35, v34 wave_shr:1 row_mask:0xf bank_mask:0xf
    v_mfma_f32_16x16x32_bf16 v[40:43], v[96:99], v[216:219], v[40:43]
    v_add_f32_dpp v17, v12, v33 wave_ror:1 row_mask:0xf bank_mask:0xf
    v_add_f32_dpp v17, v16, v33 wave_shr:1 row_mask:0xf bank_mask:0xf
    v_mfma_f32_16x16x32_bf16 v[40:43], v[104:107], v[212:215], v[40:43]
    v_add_f32_dpp v18, v13, v32 wave_ror:1 row_mask:0xf bank_mask:0xf
    v_add_f32_dpp v18, v17, v32 wave_shr:1 row_mask:0xf bank_mask:0xf
    v_mfma_f32_16x16x32_bf16 v[40:43], v[112:115], v[208:211], v[40:43]
    ds_write_b32 v4, v18 offset:4608
    v_mfma_f32_16x16x32_bf16 v[40:43], v[120:123], v[204:207], v[40:43]
    v_add_f32_dpp v20, v35, v38 wave_ror:1 row_mask:0xf bank_mask:0xf
    v_add_f32_dpp v20, v39, v38 wave_shr:1 row_mask:0xf bank_mask:0xf
    v_mfma_f32_16x16x32_bf16 v[40:43], v[128:131], v[200:203], v[40:43]
    v_add_f32_dpp v21, v16, v37 wave_ror:1 row_mask:0xf bank_mask:0xf
    v_add_f32_dpp v21, v20, v37 wave_shr:1 row_mask:0xf bank_mask:0xf
    v_mfma_f32_16x16x32_bf16 v[40:43], v[136:139], v[196:199], v[40:43]
    v_add_f32_dpp v22, v17, v36 wave_ror:1 row_mask:0xf bank_mask:0xf
    v_add_f32_dpp v22, v21, v36 wave_shr:1 row_mask:0xf bank_mask:0xf
    v_mfma_f32_16x16x32_bf16 v[40:43], v[144:147], v[192:195], v[40:43]
    ds_write_b32 v4, v22 offset:4864
    s_waitcnt lgkmcnt(11)
    v_cmp_ne_u32 vcc, 1, v7
    s_cbranch_vccnz L_us3
L_ub3:
    s_nop 0
    v_mfma_f32_16x16x32_bf16 v[44:47], v[68:71], v[232:235], 0
    ds_read_b64 v[160:161], v3 offset:224
    ds_read_b64 v[162:163], v3 offset:232
    v_mfma_f32_16x16x32_bf16 v[44:47], v[76:79], v[228:231], v[44:47]
    v_mov_b32_e64 v61, 20
    v_add_f32_dpp v8, v39, v42 wave_ror:1 row_mask:0xf bank_mask:0xf
    v_mfma_f32_16x16x32_bf16 v[44:47], v[84:87], v[224:227], v[44:47]
    ds_write_b32 v5, v61
    v_mfma_f32_16x16x32_bf16 v[44:47], v[92:95], v[220:223], v[44:47]
    v_add_f32_dpp v8, v43, v42 wave_shr:1 row_mask:0xf bank_mask:0xf
    v_add_f32_dpp v9, v20, v41 wave_ror:1 row_mask:0xf bank_mask:0xf
    v_mfma_f32_16x16x32_bf16 v[44:47], v[100:103], v[216:219], v[44:47]
    v_add_f32_dpp v9, v8, v41 wave_shr:1 row_mask:0xf bank_mask:0xf
    v_add_f32_dpp v10, v21, v40 wave_ror:1 row_mask:0xf bank_mask:0xf
    v_mfma_f32_16x16x32_bf16 v[44:47], v[108:111], v[212:215], v[44:47]
    v_add_f32_dpp v10, v9, v40 wave_shr:1 row_mask:0xf bank_mask:0xf
    v_mfma_f32_16x16x32_bf16 v[44:47], v[116:119], v[208:211], v[44:47]
    ds_write_b32 v4, v10 offset:5120
    v_mfma_f32_16x16x32_bf16 v[44:47], v[124:127], v[204:207], v[44:47]
    v_mfma_f32_16x16x32_bf16 v[44:47], v[132:135], v[200:203], v[44:47]
    v_mfma_f32_16x16x32_bf16 v[44:47], v[140:143], v[196:199], v[44:47]
    v_mfma_f32_16x16x32_bf16 v[44:47], v[148:151], v[192:195], v[44:47]
    v_mfma_f32_16x16x32_bf16 v[48:51], v[64:67], v[236:239], 0
    ds_read_b64 v[164:165], v3 offset:192
    ds_read_b64 v[166:167], v3 offset:200
    v_mfma_f32_16x16x32_bf16 v[48:51], v[72:75], v[232:235], v[48:51]
    ds_read_b64_tr_b16 v[244:245], v2 offset:3328
    ds_read_b64_tr_b16 v[246:247], v2 offset:3360
    v_mfma_f32_16x16x32_bf16 v[48:51], v[80:83], v[228:231], v[48:51]
    v_mfma_f32_16x16x32_bf16 v[48:51], v[88:91], v[224:227], v[48:51]
    v_add_f32_dpp v12, v43, v46 wave_ror:1 row_mask:0xf bank_mask:0xf
    v_add_f32_dpp v12, v47, v46 wave_shr:1 row_mask:0xf bank_mask:0xf
    v_mfma_f32_16x16x32_bf16 v[48:51], v[96:99], v[220:223], v[48:51]
    v_add_f32_dpp v13, v8, v45 wave_ror:1 row_mask:0xf bank_mask:0xf
    v_add_f32_dpp v13, v12, v45 wave_shr:1 row_mask:0xf bank_mask:0xf
    v_mfma_f32_16x16x32_bf16 v[48:51], v[104:107], v[216:219], v[48:51]
    v_add_f32_dpp v14, v9, v44 wave_ror:1 row_mask:0xf bank_mask:0xf
    v_add_f32_dpp v14, v13, v44 wave_shr:1 row_mask:0xf bank_mask:0xf
    v_mfma_f32_16x16x32_bf16 v[48:51], v[112:115], v[212:215], v[48:51]
    ds_write_b32 v4, v14 offset:5376
    v_mfma_f32_16x16x32_bf16 v[48:51], v[120:123], v[208:211], v[48:51]
    v_mov_b32_e64 v61, 22
    v_mfma_f32_16x16x32_bf16 v[48:51], v[128:131], v[204:207], v[48:51]
    ds_write_b32 v5, v61
    v_mfma_f32_16x16x32_bf16 v[48:51], v[136:139], v[200:203], v[48:51]
    v_mfma_f32_16x16x32_bf16 v[48:51], v[144:147], v[196:199], v[48:51]
    s_waitcnt lgkmcnt(15)
    s_nop 0
    v_mfma_f32_16x16x32_bf16 v[48:51], v[152:155], v[192:195], v[48:51]
    v_mfma_f32_16x16x32_bf16 v[52:55], v[68:71], v[236:239], 0
    ds_read_b64 v[168:169], v3 offset:160
    ds_read_b64 v[170:171], v3 offset:168
    v_mfma_f32_16x16x32_bf16 v[52:55], v[76:79], v[232:235], v[52:55]
    v_mfma_f32_16x16x32_bf16 v[52:55], v[84:87], v[228:231], v[52:55]
    v_mfma_f32_16x16x32_bf16 v[52:55], v[92:95], v[224:227], v[52:55]
    v_mfma_f32_16x16x32_bf16 v[52:55], v[100:103], v[220:223], v[52:55]
    v_mfma_f32_16x16x32_bf16 v[52:55], v[108:111], v[216:219], v[52:55]
    v_add_f32_dpp v16, v47, v50 wave_ror:1 row_mask:0xf bank_mask:0xf
    v_add_f32_dpp v16, v51, v50 wave_shr:1 row_mask:0xf bank_mask:0xf
    v_mfma_f32_16x16x32_bf16 v[52:55], v[116:119], v[212:215], v[52:55]
    v_add_f32_dpp v17, v12, v49 wave_ror:1 row_mask:0xf bank_mask:0xf
    v_add_f32_dpp v17, v16, v49 wave_shr:1 row_mask:0xf bank_mask:0xf
    v_mfma_f32_16x16x32_bf16 v[52:55], v[124:127], v[208:211], v[52:55]
    v_add_f32_dpp v18, v13, v48 wave_ror:1 row_mask:0xf bank_mask:0xf
    v_add_f32_dpp v18, v17, v48 wave_shr:1 row_mask:0xf bank_mask:0xf
    v_mfma_f32_16x16x32_bf16 v[52:55], v[132:135], v[204:207], v[52:55]
    ds_write_b32 v4, v18 offset:5632
    v_mfma_f32_16x16x32_bf16 v[52:55], v[140:143], v[200:203], v[52:55]
    v_mfma_f32_16x16x32_bf16 v[52:55], v[148:151], v[196:199], v[52:55]
    v_mfma_f32_16x16x32_bf16 v[52:55], v[156:159], v[192:195], v[52:55]
    s_waitcnt lgkmcnt(15)
    s_nop 0
    v_mfma_f32_16x16x32_bf16 v[24:27], v[64:67], v[240:243], 0
    ds_read_b64 v[172:173], v3 offset:128
    ds_read_b64 v[174:175], v3 offset:136
    v_mfma_f32_16x16x32_bf16 v[24:27], v[72:75], v[236:239], v[24:27]
    ds_read_b64_tr_b16 v[248:249], v2 offset:3584
    ds_read_b64_tr_b16 v[250:251], v2 offset:3616
    v_mfma_f32_16x16x32_bf16 v[24:27], v[80:83], v[232:235], v[24:27]
    v_mfma_f32_16x16x32_bf16 v[24:27], v[88:91], v[228:231], v[24:27]
    v_add_f32_dpp v20, v51, v54 wave_ror:1 row_mask:0xf bank_mask:0xf
    v_add_f32_dpp v20, v55, v54 wave_shr:1 row_mask:0xf bank_mask:0xf
    v_mfma_f32_16x16x32_bf16 v[24:27], v[96:99], v[224:227], v[24:27]
    v_add_f32_dpp v21, v16, v53 wave_ror:1 row_mask:0xf bank_mask:0xf
    v_add_f32_dpp v21, v20, v53 wave_shr:1 row_mask:0xf bank_mask:0xf
    v_mfma_f32_16x16x32_bf16 v[24:27], v[104:107], v[220:223], v[24:27]
    v_add_f32_dpp v22, v17, v52 wave_ror:1 row_mask:0xf bank_mask:0xf
    v_add_f32_dpp v22, v21, v52 wave_shr:1 row_mask:0xf bank_mask:0xf
    v_mfma_f32_16x16x32_bf16 v[24:27], v[112:115], v[216:219], v[24:27]
    ds_write_b32 v4, v22 offset:5888
    v_mfma_f32_16x16x32_bf16 v[24:27], v[120:123], v[212:215], v[24:27]
    v_mov_b32_e64 v61, 24
    v_mfma_f32_16x16x32_bf16 v[24:27], v[128:131], v[208:211], v[24:27]
    ds_write_b32 v5, v61
    v_mfma_f32_16x16x32_bf16 v[24:27], v[136:139], v[204:207], v[24:27]
    v_mfma_f32_16x16x32_bf16 v[24:27], v[144:147], v[200:203], v[24:27]
    v_mfma_f32_16x16x32_bf16 v[24:27], v[152:155], v[196:199], v[24:27]
    s_waitcnt lgkmcnt(15)
    s_nop 0
    v_mfma_f32_16x16x32_bf16 v[24:27], v[160:163], v[192:195], v[24:27]
    v_mfma_f32_16x16x32_bf16 v[28:31], v[68:71], v[240:243], 0
    ds_read_b64 v[176:177], v3 offset:96
    ds_read_b64 v[178:179], v3 offset:104
    v_mfma_f32_16x16x32_bf16 v[28:31], v[76:79], v[236:239], v[28:31]
    v_mfma_f32_16x16x32_bf16 v[28:31], v[84:87], v[232:235], v[28:31]
    v_mfma_f32_16x16x32_bf16 v[28:31], v[92:95], v[228:231], v[28:31]
    v_mfma_f32_16x16x32_bf16 v[28:31], v[100:103], v[224:227], v[28:31]
    v_mfma_f32_16x16x32_bf16 v[28:31], v[108:111], v[220:223], v[28:31]
    v_add_f32_dpp v8, v55, v26 wave_ror:1 row_mask:0xf bank_mask:0xf
    v_add_f32_dpp v8, v27, v26 wave_shr:1 row_mask:0xf bank_mask:0xf
    v_mfma_f32_16x16x32_bf16 v[28:31], v[116:119], v[216:219], v[28:31]
    v_add_f32_dpp v9, v20, v25 wave_ror:1 row_mask:0xf bank_mask:0xf
    v_add_f32_dpp v9, v8, v25 wave_shr:1 row_mask:0xf bank_mask:0xf
    v_mfma_f32_16x16x32_bf16 v[28:31], v[124:127], v[212:215], v[28:31]
    v_add_f32_dpp v10, v21, v24 wave_ror:1 row_mask:0xf bank_mask:0xf
    v_add_f32_dpp v10, v9, v24 wave_shr:1 row_mask:0xf bank_mask:0xf
    v_mfma_f32_16x16x32_bf16 v[28:31], v[132:135], v[208:211], v[28:31]
    ds_write_b32 v4, v10 offset:6144
    v_mfma_f32_16x16x32_bf16 v[28:31], v[140:143], v[204:207], v[28:31]
    v_mfma_f32_16x16x32_bf16 v[28:31], v[148:151], v[200:203], v[28:31]
    v_mfma_f32_16x16x32_bf16 v[28:31], v[156:159], v[196:199], v[28:31]
    s_waitcnt lgkmcnt(15)
    s_nop 0
    v_mfma_f32_16x16x32_bf16 v[28:31], v[164:167], v[192:195], v[28:31]
    s_waitcnt lgkmcnt(14)
    s_nop 0
    v_mfma_f32_16x16x32_bf16 v[32:35], v[64:67], v[244:247], 0
    ds_read_b64 v[180:181], v3 offset:64
    ds_read_b64 v[182:183], v3 offset:72
    v_mfma_f32_16x16x32_bf16 v[32:35], v[72:75], v[240:243], v[32:35]
    ds_read_b64_tr_b16 v[252:253], v2 offset:3840
    ds_read_b64_tr_b16 v[254:255], v2 offset:3872
    v_mfma_f32_16x16x32_bf16 v[32:35], v[80:83], v[236:239], v[32:35]
    v_mfma_f32_16x16x32_bf16 v[32:35], v[88:91], v[232:235], v[32:35]
    v_add_f32_dpp v12, v27, v30 wave_ror:1 row_mask:0xf bank_mask:0xf
    v_add_f32_dpp v12, v31, v30 wave_shr:1 row_mask:0xf bank_mask:0xf
    v_mfma_f32_16x16x32_bf16 v[32:35], v[96:99], v[228:231], v[32:35]
    v_add_f32_dpp v13, v8, v29 wave_ror:1 row_mask:0xf bank_mask:0xf
    v_add_f32_dpp v13, v12, v29 wave_shr:1 row_mask:0xf bank_mask:0xf
    v_mfma_f32_16x16x32_bf16 v[32:35], v[104:107], v[224:227], v[32:35]
    v_add_f32_dpp v14, v9, v28 wave_ror:1 row_mask:0xf bank_mask:0xf
    v_add_f32_dpp v14, v13, v28 wave_shr:1 row_mask:0xf bank_mask:0xf
    v_mfma_f32_16x16x32_bf16 v[32:35], v[112:115], v[220:223], v[32:35]
    ds_write_b32 v4, v14 offset:6400
    v_mfma_f32_16x16x32_bf16 v[32:35], v[120:123], v[216:219], v[32:35]
    v_mov_b32_e64 v61, 26
    v_mfma_f32_16x16x32_bf16 v[32:35], v[128:131], v[212:215], v[32:35]
    ds_write_b32 v5, v61
    v_mfma_f32_16x16x32_bf16 v[32:35], v[136:139], v[208:211], v[32:35]
    v_mfma_f32_16x16x32_bf16 v[32:35], v[144:147], v[204:207], v[32:35]
    v_mfma_f32_16x16x32_bf16 v[32:35], v[152:155], v[200:203], v[32:35]
    v_mfma_f32_16x16x32_bf16 v[32:35], v[160:163], v[196:199], v[32:35]
    s_waitcnt lgkmcnt(15)
    s_nop 0
    v_mfma_f32_16x16x32_bf16 v[32:35], v[168:171], v[192:195], v[32:35]
    v_mfma_f32_16x16x32_bf16 v[36:39], v[68:71], v[244:247], 0
    ds_read_b64 v[184:185], v3 offset:32
    ds_read_b64 v[186:187], v3 offset:40
    v_mfma_f32_16x16x32_bf16 v[36:39], v[76:79], v[240:243], v[36:39]
    v_mfma_f32_16x16x32_bf16 v[36:39], v[84:87], v[236:239], v[36:39]
    v_mfma_f32_16x16x32_bf16 v[36:39], v[92:95], v[232:235], v[36:39]
    v_mfma_f32_16x16x32_bf16 v[36:39], v[100:103], v[228:231], v[36:39]
    v_mfma_f32_16x16x32_bf16 v[36:39], v[108:111], v[224:227], v[36:39]
    v_add_f32_dpp v16, v31, v34 wave_ror:1 row_mask:0xf bank_mask:0xf
    v_add_f32_dpp v16, v35, v34 wave_shr:1 row_mask:0xf bank_mask:0xf
    v_mfma_f32_16x16x32_bf16 v[36:39], v[116:119], v[220:223], v[36:39]
    v_add_f32_dpp v17, v12, v33 wave_ror:1 row_mask:0xf bank_mask:0xf
    v_add_f32_dpp v17, v16, v33 wave_shr:1 row_mask:0xf bank_mask:0xf
    v_mfma_f32_16x16x32_bf16 v[36:39], v[124:127], v[216:219], v[36:39]
    v_add_f32_dpp v18, v13, v32 wave_ror:1 row_mask:0xf bank_mask:0xf
    v_add_f32_dpp v18, v17, v32 wave_shr:1 row_mask:0xf bank_mask:0xf
    v_mfma_f32_16x16x32_bf16 v[36:39], v[132:135], v[212:215], v[36:39]
    ds_write_b32 v4, v18 offset:6656
    v_mfma_f32_16x16x32_bf16 v[36:39], v[140:143], v[208:211], v[36:39]
    v_mfma_f32_16x16x32_bf16 v[36:39], v[148:151], v[204:207], v[36:39]
    v_mfma_f32_16x16x32_bf16 v[36:39], v[156:159], v[200:203], v[36:39]
    v_mfma_f32_16x16x32_bf16 v[36:39], v[164:167], v[196:199], v[36:39]
    s_waitcnt lgkmcnt(15)
    s_nop 0
    v_mfma_f32_16x16x32_bf16 v[36:39], v[172:175], v[192:195], v[36:39]
    s_waitcnt lgkmcnt(14)
    s_nop 0
    v_mfma_f32_16x16x32_bf16 v[40:43], v[64:67], v[248:251], 0
    ds_read_b64 v[188:189], v3 offset:0
    ds_read_b64 v[190:191], v3 offset:8
    v_mfma_f32_16x16x32_bf16 v[40:43], v[72:75], v[244:247], v[40:43]
    v_mfma_f32_16x16x32_bf16 v[40:43], v[80:83], v[240:243], v[40:43]
    v_mfma_f32_16x16x32_bf16 v[40:43], v[88:91], v[236:239], v[40:43]
    v_mfma_f32_16x16x32_bf16 v[40:43], v[96:99], v[232:235], v[40:43]
    v_mfma_f32_16x16x32_bf16 v[40:43], v[104:107], v[228:231], v[40:43]
    v_add_f32_dpp v20, v35, v38 wave_ror:1 row_mask:0xf bank_mask:0xf
    v_add_f32_dpp v20, v39, v38 wave_shr:1 row_mask:0xf bank_mask:0xf
    v_mfma_f32_16x16x32_bf16 v[40:43], v[112:115], v[224:227], v[40:43]
    v_add_f32_dpp v21, v16, v37 wave_ror:1 row_mask:0xf bank_mask:0xf
    v_add_f32_dpp v21, v20, v37 wave_shr:1 row_mask:0xf bank_mask:0xf
    v_mfma_f32_16x16x32_bf16 v[40:43], v[120:123], v[220:223], v[40:43]
    v_add_f32_dpp v22, v17, v36 wave_ror:1 row_mask:0xf bank_mask:0xf
    v_add_f32_dpp v22, v21, v36 wave_shr:1 row_mask:0xf bank_mask:0xf
    v_mfma_f32_16x16x32_bf16 v[40:43], v[128:131], v[216:219], v[40:43]
    ds_write_b32 v4, v22 offset:6912
    v_mfma_f32_16x16x32_bf16 v[40:43], v[136:139], v[212:215], v[40:43]
    v_mov_b32_e64 v61, 28
    v_mfma_f32_16x16x32_bf16 v[40:43], v[144:147], v[208:211], v[40:43]
    ds_write_b32 v5, v61
    v_mfma_f32_16x16x32_bf16 v[40:43], v[152:155], v[204:207], v[40:43]
    v_mfma_f32_16x16x32_bf16 v[40:43], v[160:163], v[200:203], v[40:43]
    v_mfma_f32_16x16x32_bf16 v[40:43], v[168:171], v[196:199], v[40:43]
    s_waitcnt lgkmcnt(14)
    s_nop 0
    v_mfma_f32_16x16x32_bf16 v[40:43], v[176:179], v[192:195], v[40:43]
    v_mfma_f32_16x16x32_bf16 v[44:47], v[68:71], v[248:251], 0
    v_mfma_f32_16x16x32_bf16 v[44:47], v[76:79], v[244:247], v[44:47]
    v_mfma_f32_16x16x32_bf16 v[44:47], v[84:87], v[240:243], v[44:47]
    v_mfma_f32_16x16x32_bf16 v[44:47], v[92:95], v[236:239], v[44:47]
    v_mfma_f32_16x16x32_bf16 v[44:47], v[100:103], v[232:235], v[44:47]
    v_mfma_f32_16x16x32_bf16 v[44:47], v[108:111], v[228:231], v[44:47]
    v_mfma_f32_16x16x32_bf16 v[44:47], v[116:119], v[224:227], v[44:47]
    v_mfma_f32_16x16x32_bf16 v[44:47], v[124:127], v[220:223], v[44:47]
    v_add_f32_dpp v8, v39, v42 wave_ror:1 row_mask:0xf bank_mask:0xf
    v_add_f32_dpp v8, v43, v42 wave_shr:1 row_mask:0xf bank_mask:0xf
    v_mfma_f32_16x16x32_bf16 v[44:47], v[132:135], v[216:219], v[44:47]
    v_add_f32_dpp v9, v20, v41 wave_ror:1 row_mask:0xf bank_mask:0xf
    v_add_f32_dpp v9, v8, v41 wave_shr:1 row_mask:0xf bank_mask:0xf
    v_mfma_f32_16x16x32_bf16 v[44:47], v[140:143], v[212:215], v[44:47]
    v_add_f32_dpp v10, v21, v40 wave_ror:1 row_mask:0xf bank_mask:0xf
    v_add_f32_dpp v10, v9, v40 wave_shr:1 row_mask:0xf bank_mask:0xf
    v_mfma_f32_16x16x32_bf16 v[44:47], v[148:151], v[208:211], v[44:47]
    ds_write_b32 v4, v10 offset:7168
    v_mfma_f32_16x16x32_bf16 v[44:47], v[156:159], v[204:207], v[44:47]
    v_mov_b32_e64 v61, 29
    v_mfma_f32_16x16x32_bf16 v[44:47], v[164:167], v[200:203], v[44:47]
    ds_write_b32 v5, v61
    v_mfma_f32_16x16x32_bf16 v[44:47], v[172:175], v[196:199], v[44:47]
    s_waitcnt lgkmcnt(13)
    s_nop 0
    v_mfma_f32_16x16x32_bf16 v[44:47], v[180:183], v[192:195], v[44:47]
    s_waitcnt lgkmcnt(11)
    s_nop 0
    v_mfma_f32_16x16x32_bf16 v[48:51], v[64:67], v[252:255], 0
    v_mfma_f32_16x16x32_bf16 v[48:51], v[72:75], v[248:251], v[48:51]
    v_mfma_f32_16x16x32_bf16 v[48:51], v[80:83], v[244:247], v[48:51]
    v_mfma_f32_16x16x32_bf16 v[48:51], v[88:91], v[240:243], v[48:51]
    v_mfma_f32_16x16x32_bf16 v[48:51], v[96:99], v[236:239], v[48:51]
    v_mfma_f32_16x16x32_bf16 v[48:51], v[104:107], v[232:235], v[48:51]
    v_mfma_f32_16x16x32_bf16 v[48:51], v[112:115], v[228:231], v[48:51]
    v_mfma_f32_16x16x32_bf16 v[48:51], v[120:123], v[224:227], v[48:51]
    v_add_f32_dpp v12, v43, v46 wave_ror:1 row_mask:0xf bank_mask:0xf
    v_add_f32_dpp v12, v47, v46 wave_shr:1 row_mask:0xf bank_mask:0xf
    v_mfma_f32_16x16x32_bf16 v[48:51], v[128:131], v[220:223], v[48:51]
    v_add_f32_dpp v13, v8, v45 wave_ror:1 row_mask:0xf bank_mask:0xf
    v_add_f32_dpp v13, v12, v45 wave_shr:1 row_mask:0xf bank_mask:0xf
    v_mfma_f32_16x16x32_bf16 v[48:51], v[136:139], v[216:219], v[48:51]
    v_add_f32_dpp v14, v9, v44 wave_ror:1 row_mask:0xf bank_mask:0xf
    v_add_f32_dpp v14, v13, v44 wave_shr:1 row_mask:0xf bank_mask:0xf
    v_mfma_f32_16x16x32_bf16 v[48:51], v[144:147], v[212:215], v[48:51]
    ds_write_b32 v4, v14 offset:7424
    v_mfma_f32_16x16x32_bf16 v[48:51], v[152:155], v[208:211], v[48:51]
    v_mov_b32_e64 v61, 30
    v_mfma_f32_16x16x32_bf16 v[48:51], v[160:163], v[204:207], v[48:51]
    ds_write_b32 v5, v61
    v_mfma_f32_16x16x32_bf16 v[48:51], v[168:171], v[200:203], v[48:51]
    v_mfma_f32_16x16x32_bf16 v[48:51], v[176:179], v[196:199], v[48:51]
    s_waitcnt lgkmcnt(9)
    s_nop 0
    v_mfma_f32_16x16x32_bf16 v[48:51], v[184:187], v[192:195], v[48:51]
    v_mfma_f32_16x16x32_bf16 v[52:55], v[68:71], v[252:255], 0
    v_mfma_f32_16x16x32_bf16 v[52:55], v[76:79], v[248:251], v[52:55]
    v_mfma_f32_16x16x32_bf16 v[52:55], v[84:87], v[244:247], v[52:55]
    v_mfma_f32_16x16x32_bf16 v[52:55], v[92:95], v[240:243], v[52:55]
    v_mfma_f32_16x16x32_bf16 v[52:55], v[100:103], v[236:239], v[52:55]
    v_mfma_f32_16x16x32_bf16 v[52:55], v[108:111], v[232:235], v[52:55]
    v_mfma_f32_16x16x32_bf16 v[52:55], v[116:119], v[228:231], v[52:55]
    v_mfma_f32_16x16x32_bf16 v[52:55], v[124:127], v[224:227], v[52:55]
    v_add_f32_dpp v16, v47, v50 wave_ror:1 row_mask:0xf bank_mask:0xf
    v_add_f32_dpp v16, v51, v50 wave_shr:1 row_mask:0xf bank_mask:0xf
    v_mfma_f32_16x16x32_bf16 v[52:55], v[132:135], v[220:223], v[52:55]
    v_add_f32_dpp v17, v12, v49 wave_ror:1 row_mask:0xf bank_mask:0xf
    v_add_f32_dpp v17, v16, v49 wave_shr:1 row_mask:0xf bank_mask:0xf
    v_mfma_f32_16x16x32_bf16 v[52:55], v[140:143], v[216:219], v[52:55]
    v_add_f32_dpp v18, v13, v48 wave_ror:1 row_mask:0xf bank_mask:0xf
    v_add_f32_dpp v18, v17, v48 wave_shr:1 row_mask:0xf bank_mask:0xf
    v_mfma_f32_16x16x32_bf16 v[52:55], v[148:151], v[212:215], v[52:55]
    ds_write_b32 v4, v18 offset:7680
    v_mfma_f32_16x16x32_bf16 v[52:55], v[156:159], v[208:211], v[52:55]
    v_mov_b32_e64 v61, 31
    v_mfma_f32_16x16x32_bf16 v[52:55], v[164:167], v[204:207], v[52:55]
    ds_write_b32 v5, v61
    v_mfma_f32_16x16x32_bf16 v[52:55], v[172:175], v[200:203], v[52:55]
    v_mfma_f32_16x16x32_bf16 v[52:55], v[180:183], v[196:199], v[52:55]
    s_waitcnt lgkmcnt(8)
    s_nop 0
    v_mfma_f32_16x16x32_bf16 v[52:55], v[188:191], v[192:195], v[52:55]
    s_nop 0
    s_nop 0
    s_nop 0
    s_nop 0
    s_nop 0
    s_nop 0
    s_nop 0
    s_nop 0
    v_add_f32_dpp v20, v51, v54 wave_ror:1 row_mask:0xf bank_mask:0xf
    v_add_f32_dpp v20, v55, v54 wave_shr:1 row_mask:0xf bank_mask:0xf
    v_add_f32_dpp v21, v16, v53 wave_ror:1 row_mask:0xf bank_mask:0xf
    s_nop 0
    s_nop 0
    v_add_f32_dpp v21, v20, v53 wave_shr:1 row_mask:0xf bank_mask:0xf
    v_add_f32_dpp v22, v17, v52 wave_ror:1 row_mask:0xf bank_mask:0xf
    s_nop 0
    s_nop 0
    v_add_f32_dpp v22, v21, v52 wave_shr:1 row_mask:0xf bank_mask:0xf
    v_mov_b32_e64 v61, 32
    ds_write_b32 v4, v22 offset:7936
    ds_write_b32 v5, v61
    s_endpgm
L_us1:
    s_mov_b32 s65, 0
L_w3:
    ds_read_b32 v7, v6 offset:32
    s_waitcnt lgkmcnt(0)
    v_cmp_ne_u32 vcc, 1, v7
    s_cbranch_vccz L_w3_ok
    s_add_u32 s65, s65, 1
    s_bitcmp0_b32 s65, 19
    s_cbranch_scc1 L_w3
L_w3_ok:
    s_branch L_ub1
L_us2:
    s_mov_b32 s65, 0
L_w4:
    ds_read_b32 v7, v6 offset:64
    s_waitcnt lgkmcnt(0)
    v_cmp_ne_u32 vcc, 1, v7
    s_cbranch_vccz L_w4_ok
    s_add_u32 s65, s65, 1
    s_bitcmp0_b32 s65, 19
    s_cbranch_scc1 L_w4
L_w4_ok:
    s_branch L_ub2
L_us3:
    s_mov_b32 s65, 0
L_w5:
    ds_read_b32 v7, v6 offset:96
    s_waitcnt lgkmcnt(0)
    v_cmp_ne_u32 vcc, 1, v7
    s_cbranch_vccz L_w5_ok
    s_add_u32 s65, s65, 1
    s_bitcmp0_b32 s65, 19
    s_cbranch_scc1 L_w5
L_w5_ok:
    s_branch L_ub3
L_mknon:
    s_memrealtime s[12:13]
    s_mov_b64 exec, 1
    v_mov_b32 v3, 0
    v_mov_b32 v4, 0
    s_waitcnt lgkmcnt(0)
    s_or_b32 s12, s12, 1
    v_mov_b32 v2, s12
    global_atomic_cmpswap v4, v[2:3], s[50:51] sc1
    s_mov_b64 exec, -1
    s_branch L_nonon
L_g7:
    s_lshl_b32 s8, s5, 3
    s_add_u32 s8, s8, s6
    s_lshl_b32 s9, s8, 3
    v_lshrrev_b32 v7, 3, v1
    v_add_u32 v7, s9, v7
    v_and_b32 v6, 7, v1
    v_mul_u32_u24 v6, 112, v6
    v_mul_u32_u24 v7, 896, v7
    v_add_u32 v7, v7, v6
    s_lshl_b32 s9, s8, 5
    s_add_u32 s9, s9, 3670016
    v_lshrrev_b32 v5, 4, v1
    v_lshl_add_u32 v5, v5, 3, s9
    v_mov_b32 v4, 0
    s_waitcnt lgkmcnt(0)
    global_load_dwordx4 v[40:43], v6, s[46:47] offset:0
    global_load_dwordx4 v[44:47], v6, s[46:47] offset:16
    global_load_dwordx4 v[48:51], v6, s[46:47] offset:32
    global_load_dwordx4 v[52:55], v6, s[46:47] offset:48
    global_load_dwordx4 v[56:59], v6, s[46:47] offset:64
    global_load_dwordx4 v[60:63], v6, s[46:47] offset:80
    global_load_dwordx4 v[64:67], v6, s[46:47] offset:96
    global_load_dword v70, v4, s[50:51] sc1
    s_waitcnt vmcnt(0)
    s_mov_b32 s65, 0
L_nong:
    v_readfirstlane_b32 s70, v70
    s_nop 0
    s_cmp_lg_u32 s70, 0
    s_cbranch_scc1 L_nong_ok
    s_sleep 4
    global_load_dword v70, v4, s[50:51] sc1
    s_waitcnt vmcnt(0)
    s_add_u32 s65, s65, 1
    s_bitcmp0_b32 s65, 16
    s_cbranch_scc1 L_nong
L_nong_ok:
    global_load_dwordx4 v[8:11], v7, s[16:17] offset:0
    global_load_dwordx4 v[12:15], v7, s[16:17] offset:16
    global_load_dwordx4 v[16:19], v7, s[16:17] offset:32
    global_load_dwordx4 v[20:23], v7, s[16:17] offset:48
    global_load_dwordx4 v[24:27], v7, s[16:17] offset:64
    global_load_dwordx4 v[28:31], v7, s[16:17] offset:80
    global_load_dwordx4 v[32:35], v7, s[16:17] offset:96
    v_mov_b32 v2, 0
    v_mov_b32 v3, 0
    s_waitcnt vmcnt(6)
    v_dot2_f32_bf16 v2, v8, v40, v2
    v_dot2_f32_bf16 v3, v9, v41, v3
    v_dot2_f32_bf16 v2, v10, v42, v2
    v_dot2_f32_bf16 v3, v11, v43, v3
    s_waitcnt vmcnt(5)
    v_dot2_f32_bf16 v2, v12, v44, v2
    v_dot2_f32_bf16 v3, v13, v45, v3
    v_dot2_f32_bf16 v2, v14, v46, v2
    v_dot2_f32_bf16 v3, v15, v47, v3
    s_waitcnt vmcnt(4)
    v_dot2_f32_bf16 v2, v16, v48, v2
    v_dot2_f32_bf16 v3, v17, v49, v3
    v_dot2_f32_bf16 v2, v18, v50, v2
    v_dot2_f32_bf16 v3, v19, v51, v3
    s_waitcnt vmcnt(3)
    v_dot2_f32_bf16 v2, v20, v52, v2
    v_dot2_f32_bf16 v3, v21, v53, v3
    v_dot2_f32_bf16 v2, v22, v54, v2
    v_dot2_f32_bf16 v3, v23, v55, v3
    s_waitcnt vmcnt(2)
    v_dot2_f32_bf16 v2, v24, v56, v2
    v_dot2_f32_bf16 v3, v25, v57, v3
    v_dot2_f32_bf16 v2, v26, v58, v2
    v_dot2_f32_bf16 v3, v27, v59, v3
    s_waitcnt vmcnt(1)
    v_dot2_f32_bf16 v2, v28, v60, v2
    v_dot2_f32_bf16 v3, v29, v61, v3
    v_dot2_f32_bf16 v2, v30, v62, v2
    v_dot2_f32_bf16 v3, v31, v63, v3
    s_waitcnt vmcnt(0)
    v_dot2_f32_bf16 v2, v32, v64, v2
    v_dot2_f32_bf16 v3, v33, v65, v3
    v_dot2_f32_bf16 v2, v34, v66, v2
    v_dot2_f32_bf16 v3, v35, v67, v3
    s_nop 2
    v_add_f32 v2, v2, v3
    s_nop 1
    v_add_f32_dpp v2, v2, v2 row_shr:1 row_mask:0xf bank_mask:0xf bound_ctrl:0
    s_nop 1
    v_add_f32_dpp v2, v2, v2 row_shr:2 row_mask:0xf bank_mask:0xf bound_ctrl:0
    s_nop 1
    v_add_f32_dpp v2, v2, v2 row_shr:4 row_mask:0xf bank_mask:0xf bound_ctrl:0
    v_cvt_pk_bf16_f32 v2, 0, v2
    v_mul_f32 v2, 0xbfb8aa3b, v2
    v_exp_f32 v2, v2
    s_nop 0
    v_add_f32 v2, 1.0, v2
    v_rcp_f32 v2, v2
    s_nop 1
    v_mov_b32_dpp v3, v2 row_shr:8 row_mask:0xf bank_mask:0xf bound_ctrl:0
    v_cvt_pk_bf16_f32 v2, v3, v2
    v_mov_b32 v3, s70
    s_mov_b32 exec_lo, 0x80008000
    s_mov_b32 exec_hi, 0x80008000
    global_store_dwordx2 v5, v[2:3], s[52:53] sc1
L_end:
    s_endpgm
L_codeend:
.section .rodata,"a"
.p2align 6
.amdhsa_kernel gated_mix__ssm_conv_s4__ssm_conv_h3__prompt_kernel
  .amdhsa_next_free_vgpr 256
  .amdhsa_next_free_sgpr 102
  .amdhsa_accum_offset 256
  .amdhsa_group_segment_fixed_size 0
  .amdhsa_kernarg_size 152
  .amdhsa_user_sgpr_count 2
  .amdhsa_user_sgpr_kernarg_segment_ptr 1
  .amdhsa_system_sgpr_workgroup_id_x 1
.end_amdhsa_kernel
```
